```python
import torch

def _softmax(x, axis=-1):
    return torch.softmax(x, dim=axis)
def _gelu(x):
    return torch.nn.functional.gelu(x, approximate="tanh")
def _silu(x):
    return torch.nn.functional.silu(x)
def _sigmoid(x):
    return torch.sigmoid(x)
def _layernorm(x, axis=-1, eps=1e-5):
    m = x.mean(dim=axis, keepdim=True)
    v = x.var(dim=axis, keepdim=True, unbiased=False)
    return (x - m) / torch.sqrt(v + eps)
def _scatter_add(tgt, idx, src, axis=0):
    return tgt.clone().index_add_(axis, idx, src)
def _segment_sum(src, seg, n):
    out = torch.zeros((n,) + src.shape[1:], dtype=src.dtype)
    return out.index_add_(0, seg, src)
def _pad(x, pw):
    flat = tuple(v for pair in reversed(pw) for v in pair)
    return torch.nn.functional.pad(x, flat)

kernel_name = 'sequential_preLN__grouped_kv_mqa__glu_gated_geglu__prompt'

def setup_inputs():

    _w = (lambda a: (lambda t: t.to(torch.bfloat16) if t.is_floating_point() else t)(torch.as_tensor(a)))
    def _A_setup():
        B, S, D, H = 1, 2048, 512, 32
        Dh = D // H
        return {
            "x": _w((lambda *s: torch.randn(*s, dtype=torch.bfloat16) * 0.05)(B, S, D)),
            "wq": _w((lambda *s: torch.randn(*s, dtype=torch.bfloat16) * 0.05)(D, H * Dh)),
            "wk": _w((lambda *s: torch.randn(*s, dtype=torch.bfloat16) * 0.05)(D, Dh)),
            "wv": _w((lambda *s: torch.randn(*s, dtype=torch.bfloat16) * 0.05)(D, Dh)),
            "wo": _w((lambda *s: torch.randn(*s, dtype=torch.bfloat16) * 0.05)(H * Dh, D)),
        }
    _A_in = _A_setup()

    def _B_setup():
        B, S, Dm, Df = 1, 2048, 512, 1792
        return {
            "x": _w((lambda *s: torch.randn(*s, dtype=torch.bfloat16) * 0.05)(B, S, Dm)),
            "w_gate": _w((lambda *s: torch.randn(*s, dtype=torch.bfloat16) * 0.4)(Dm, Df) * (Dm ** -0.5)),
            "w_up": _w((lambda *s: torch.randn(*s, dtype=torch.bfloat16) * 0.4)(Dm, Df) * (Dm ** -0.5)),
            "w_down": _w((lambda *s: torch.randn(*s, dtype=torch.bfloat16) * 0.4)(Df, Dm) * (Df ** -0.5)),
        }
    _B_in = _B_setup()

    return {
        "A_x": _A_in["x"],
        "A_wq": _A_in["wq"],
        "A_wk": _A_in["wk"],
        "A_wv": _A_in["wv"],
        "A_wo": _A_in["wo"],
        "B_x": _B_in["x"],
        "B_w_gate": _B_in["w_gate"],
        "B_w_up": _B_in["w_up"],
        "B_w_down": _B_in["w_down"],
    }

def reference(A_x, A_wq, A_wk, A_wv, A_wo, B_x, B_w_gate, B_w_up, B_w_down):
    def _A_ref(x, wq, wk, wv, wo):
        B, S, D = x.shape
        H = 32
        Dh = D // H
        q = (lambda x, *d: x.permute(*d))((x @ wq).reshape(B, S, H, Dh), 0, 2, 1, 3)
        k = x @ wk
        v = x @ wv
        scores = torch.einsum("bhqd,bkd->bhqk", q, k) * (Dh ** -0.5)
        p = _softmax(scores, axis=-1)
        o = torch.einsum("bhqk,bkd->bhqd", p, v)
        return (lambda x, *d: x.permute(*d))(o, 0, 2, 1, 3).reshape(B, S, H * Dh) @ wo

    def _B_ref(x, w_gate, w_up, w_down):
        g = torch.einsum("bsd,df->bsf", x, w_gate)
        u = torch.einsum("bsd,df->bsf", x, w_up)
        h = _gelu(g) * u
        return torch.einsum("bsf,fd->bsd", h, w_down)

    x = A_x
    h = x + _A_ref(_layernorm(x, axis=-1), A_wq, A_wk, A_wv, A_wo)
    h2 = h + _B_ref(_layernorm(h, axis=-1), B_w_gate, B_w_up, B_w_down)
    return h2
```

```asm
; @launch kernel=k1_qkv_kernel grid=(256,1,1) block=(512,1,1) lds=148480
; @launch kernel=k2_attn_kernel grid=(256,1,1) block=(512,1,1) lds=157840
; @launch kernel=k3_ffn_up_kernel grid=(224,1,1) block=(768,1,1) lds=147456
; @launch kernel=k4_ffn_down_kernel grid=(256,1,1) block=(512,1,1) lds=131072
.amdgcn_target "amdgcn-amd-amdhsa--gfx950"
.text
.globl k1_qkv_kernel
.p2align 8
.type k1_qkv_kernel,@function
k1_qkv_kernel:
    s_cmp_ge_u32 s2, 256
    s_cbranch_scc1 K1_END
    s_load_dwordx8 s[4:11], s[0:1], 0
    s_load_dwordx2 s[12:13], s[0:1], 32
    s_load_dwordx2 s[14:15], s[0:1], 88
    v_lshrrev_b32 v1, 6, v0
    v_and_b32 v0, 63, v0
    s_and_b32 s16, s2, 7
    s_lshl_b32 s16, s16, 2
    s_lshr_b32 s17, s2, 6
    s_add_u32 s16, s16, s17
    s_lshr_b32 s17, s2, 3
    s_and_b32 s17, s17, 7
    v_readfirstlane_b32 s18, v1
    v_lshrrev_b32 v2, 4, v0
    v_and_b32 v3, 15, v0
    s_lshl_b32 s19, s16, 6
    s_lshl_b32 s28, s18, 3
    s_add_u32 s19, s19, s28
    v_add_u32 v4, s19, v2
    v_lshlrev_b32 v4, 10, v4
    v_lshl_add_u32 v4, v3, 4, v4
    v_add_u32 v5, 4096, v4
    s_waitcnt lgkmcnt(0)

    global_load_dwordx4 v[64:67], v4, s[4:5] offset:0
    global_load_dwordx4 v[68:71], v4, s[4:5] offset:256
    global_load_dwordx4 v[72:75], v4, s[4:5] offset:512
    global_load_dwordx4 v[76:79], v4, s[4:5] offset:768
    global_load_dwordx4 v[80:83], v5, s[4:5] offset:0
    global_load_dwordx4 v[84:87], v5, s[4:5] offset:256
    global_load_dwordx4 v[88:91], v5, s[4:5] offset:512
    global_load_dwordx4 v[92:95], v5, s[4:5] offset:768
    s_mov_b32 s20, s6
    s_mov_b32 s21, s7
    s_mov_b32 s22, 524288
    s_mov_b32 s23, 0x00020000
    s_cmp_lt_u32 s17, 4
    s_cselect_b32 s24, s8, s10
    s_cselect_b32 s25, s9, s11
    s_mov_b32 s26, 16384
    s_mov_b32 s27, 0x00020000

    v_lshrrev_b32 v8, 3, v0
    v_and_b32 v9, 7, v0
    v_and_b32 v10, 1, v2
    v_lshlrev_b32 v10, 2, v10
    v_xor_b32 v9, v9, v10
    v_lshlrev_b32 v9, 4, v9
    v_lshl_add_u32 v8, v8, 10, v9
    s_lshl_b32 s36, s18, 16
    s_lshl_b32 s29, s17, 7
    s_add_u32 s36, s36, s29
    s_lshl_b32 s37, s18, 13
    s_add_u32 s37, s37, 66560
    v_lshlrev_b32 v9, 4, v0
    s_lshl_b32 s38, s18, 11
    s_add_u32 s39, s38, 132096

    s_lshl_b32 s28, s18, 3
    v_add_u32 v16, s28, v2
    s_movk_i32 s29, 1040
    v_mul_lo_u32 v16, v16, s29
    v_lshl_add_u32 v16, v3, 4, v16
    s_mov_b32 s33, 0xffff0000
    s_mov_b32 s34, 989855744
    s_mov_b32 s35, 925353388

    s_add_u32 m0, s37, 0
    s_add_u32 s28, s36, 0
    buffer_load_dwordx4 v8, s[20:23], s28 offen lds
    s_add_u32 m0, s37, 1024
    s_add_u32 s28, s36, 8192
    buffer_load_dwordx4 v8, s[20:23], s28 offen lds
    s_add_u32 m0, s37, 2048
    s_add_u32 s28, s36, 16384
    buffer_load_dwordx4 v8, s[20:23], s28 offen lds
    s_add_u32 m0, s37, 3072
    s_add_u32 s28, s36, 24576
    buffer_load_dwordx4 v8, s[20:23], s28 offen lds
    s_add_u32 m0, s37, 4096
    s_add_u32 s28, s36, 32768
    buffer_load_dwordx4 v8, s[20:23], s28 offen lds
    s_add_u32 m0, s37, 5120
    s_add_u32 s28, s36, 40960
    buffer_load_dwordx4 v8, s[20:23], s28 offen lds
    s_add_u32 m0, s37, 6144
    s_add_u32 s28, s36, 49152
    buffer_load_dwordx4 v8, s[20:23], s28 offen lds
    s_add_u32 m0, s37, 7168
    s_add_u32 s28, s36, 57344
    buffer_load_dwordx4 v8, s[20:23], s28 offen lds
    s_add_u32 m0, s39, 0
    s_add_u32 s28, s38, 0
    buffer_load_dwordx4 v9, s[24:27], s28 offen lds
    s_add_u32 m0, s39, 1024
    s_add_u32 s28, s38, 1024
    buffer_load_dwordx4 v9, s[24:27], s28 offen lds
    s_waitcnt vmcnt(14)
    v_lshlrev_b32 v96, 16, v64
    v_and_b32 v97, s33, v64
    v_lshlrev_b32 v98, 16, v65
    v_and_b32 v99, s33, v65
    v_lshlrev_b32 v100, 16, v66
    v_and_b32 v101, s33, v66
    v_lshlrev_b32 v102, 16, v67
    v_and_b32 v103, s33, v67
    v_lshlrev_b32 v104, 16, v68
    v_and_b32 v105, s33, v68
    v_lshlrev_b32 v106, 16, v69
    v_and_b32 v107, s33, v69
    v_lshlrev_b32 v108, 16, v70
    v_and_b32 v109, s33, v70
    v_lshlrev_b32 v110, 16, v71
    v_and_b32 v111, s33, v71
    v_lshlrev_b32 v112, 16, v72
    v_and_b32 v113, s33, v72
    v_lshlrev_b32 v114, 16, v73
    v_and_b32 v115, s33, v73
    v_lshlrev_b32 v116, 16, v74
    v_and_b32 v117, s33, v74
    v_lshlrev_b32 v118, 16, v75
    v_and_b32 v119, s33, v75
    v_lshlrev_b32 v120, 16, v76
    v_and_b32 v121, s33, v76
    v_lshlrev_b32 v122, 16, v77
    v_and_b32 v123, s33, v77
    v_lshlrev_b32 v124, 16, v78
    v_and_b32 v125, s33, v78
    v_lshlrev_b32 v126, 16, v79
    v_and_b32 v127, s33, v79
    v_pk_add_f32 v[20:21], v[96:97], v[98:99]
    v_pk_add_f32 v[22:23], v[100:101], v[102:103]
    v_pk_add_f32 v[20:21], v[20:21], v[104:105]
    v_pk_add_f32 v[20:21], v[20:21], v[106:107]
    v_pk_add_f32 v[22:23], v[22:23], v[108:109]
    v_pk_add_f32 v[22:23], v[22:23], v[110:111]
    v_pk_add_f32 v[20:21], v[20:21], v[112:113]
    v_pk_add_f32 v[20:21], v[20:21], v[114:115]
    v_pk_add_f32 v[22:23], v[22:23], v[116:117]
    v_pk_add_f32 v[22:23], v[22:23], v[118:119]
    v_pk_add_f32 v[20:21], v[20:21], v[120:121]
    v_pk_add_f32 v[20:21], v[20:21], v[122:123]
    v_pk_add_f32 v[22:23], v[22:23], v[124:125]
    v_pk_add_f32 v[22:23], v[22:23], v[126:127]
    v_pk_add_f32 v[20:21], v[20:21], v[22:23]
    v_add_f32 v20, v20, v21
    s_nop 1
    v_add_f32_dpp v20, v20, v20 row_ror:8 row_mask:0xf bank_mask:0xf
    s_nop 1
    v_add_f32_dpp v20, v20, v20 row_ror:4 row_mask:0xf bank_mask:0xf
    s_nop 1
    v_add_f32_dpp v20, v20, v20 row_ror:2 row_mask:0xf bank_mask:0xf
    s_nop 1
    v_add_f32_dpp v20, v20, v20 row_ror:1 row_mask:0xf bank_mask:0xf
    v_mul_f32 v20, s34, v20
    v_cvt_pk_bf16_f32 v21, v20, v20
    v_lshlrev_b32 v21, 16, v21
    v_sub_f32 v24, v20, v21

    v_pk_add_f32 v[96:97], v[96:97], v[20:21] op_sel:[0,1] op_sel_hi:[1,1] neg_lo:[0,1] neg_hi:[0,1]
    v_pk_add_f32 v[98:99], v[98:99], v[20:21] op_sel:[0,1] op_sel_hi:[1,1] neg_lo:[0,1] neg_hi:[0,1]
    v_pk_add_f32 v[100:101], v[100:101], v[20:21] op_sel:[0,1] op_sel_hi:[1,1] neg_lo:[0,1] neg_hi:[0,1]
    v_pk_add_f32 v[102:103], v[102:103], v[20:21] op_sel:[0,1] op_sel_hi:[1,1] neg_lo:[0,1] neg_hi:[0,1]
    v_pk_add_f32 v[104:105], v[104:105], v[20:21] op_sel:[0,1] op_sel_hi:[1,1] neg_lo:[0,1] neg_hi:[0,1]
    v_pk_add_f32 v[106:107], v[106:107], v[20:21] op_sel:[0,1] op_sel_hi:[1,1] neg_lo:[0,1] neg_hi:[0,1]
    v_pk_add_f32 v[108:109], v[108:109], v[20:21] op_sel:[0,1] op_sel_hi:[1,1] neg_lo:[0,1] neg_hi:[0,1]
    v_pk_add_f32 v[110:111], v[110:111], v[20:21] op_sel:[0,1] op_sel_hi:[1,1] neg_lo:[0,1] neg_hi:[0,1]
    v_pk_add_f32 v[112:113], v[112:113], v[20:21] op_sel:[0,1] op_sel_hi:[1,1] neg_lo:[0,1] neg_hi:[0,1]
    v_pk_add_f32 v[114:115], v[114:115], v[20:21] op_sel:[0,1] op_sel_hi:[1,1] neg_lo:[0,1] neg_hi:[0,1]
    v_pk_add_f32 v[116:117], v[116:117], v[20:21] op_sel:[0,1] op_sel_hi:[1,1] neg_lo:[0,1] neg_hi:[0,1]
    v_pk_add_f32 v[118:119], v[118:119], v[20:21] op_sel:[0,1] op_sel_hi:[1,1] neg_lo:[0,1] neg_hi:[0,1]
    v_pk_add_f32 v[120:121], v[120:121], v[20:21] op_sel:[0,1] op_sel_hi:[1,1] neg_lo:[0,1] neg_hi:[0,1]
    v_pk_add_f32 v[122:123], v[122:123], v[20:21] op_sel:[0,1] op_sel_hi:[1,1] neg_lo:[0,1] neg_hi:[0,1]
    v_pk_add_f32 v[124:125], v[124:125], v[20:21] op_sel:[0,1] op_sel_hi:[1,1] neg_lo:[0,1] neg_hi:[0,1]
    v_pk_add_f32 v[126:127], v[126:127], v[20:21] op_sel:[0,1] op_sel_hi:[1,1] neg_lo:[0,1] neg_hi:[0,1]
    v_pk_mul_f32 v[22:23], v[96:97], v[96:97]
    v_pk_mul_f32 v[26:27], v[98:99], v[98:99]
    v_pk_fma_f32 v[22:23], v[100:101], v[100:101], v[22:23]
    v_pk_fma_f32 v[26:27], v[102:103], v[102:103], v[26:27]
    v_pk_fma_f32 v[22:23], v[104:105], v[104:105], v[22:23]
    v_pk_fma_f32 v[26:27], v[106:107], v[106:107], v[26:27]
    v_pk_fma_f32 v[22:23], v[108:109], v[108:109], v[22:23]
    v_pk_fma_f32 v[26:27], v[110:111], v[110:111], v[26:27]
    v_pk_fma_f32 v[22:23], v[112:113], v[112:113], v[22:23]
    v_pk_fma_f32 v[26:27], v[114:115], v[114:115], v[26:27]
    v_pk_fma_f32 v[22:23], v[116:117], v[116:117], v[22:23]
    v_pk_fma_f32 v[26:27], v[118:119], v[118:119], v[26:27]
    v_pk_fma_f32 v[22:23], v[120:121], v[120:121], v[22:23]
    v_pk_fma_f32 v[26:27], v[122:123], v[122:123], v[26:27]
    v_pk_fma_f32 v[22:23], v[124:125], v[124:125], v[22:23]
    v_pk_fma_f32 v[26:27], v[126:127], v[126:127], v[26:27]
    v_pk_add_f32 v[22:23], v[22:23], v[26:27]
    v_add_f32 v22, v22, v23
    s_nop 1
    v_add_f32_dpp v22, v22, v22 row_ror:8 row_mask:0xf bank_mask:0xf
    s_nop 1
    v_add_f32_dpp v22, v22, v22 row_ror:4 row_mask:0xf bank_mask:0xf
    s_nop 1
    v_add_f32_dpp v22, v22, v22 row_ror:2 row_mask:0xf bank_mask:0xf
    s_nop 1
    v_add_f32_dpp v22, v22, v22 row_ror:1 row_mask:0xf bank_mask:0xf
    v_mul_f32 v22, s34, v22
    v_fma_f32 v22, -v24, v24, v22
    v_max_f32 v22, 0, v22
    v_cvt_pk_bf16_f32 v22, v22, v22
    v_lshlrev_b32 v22, 16, v22
    v_add_f32 v22, s35, v22
    v_cvt_pk_bf16_f32 v22, v22, v22
    v_lshlrev_b32 v22, 16, v22
    v_sqrt_f32 v22, v22
    s_nop 0
    v_cvt_pk_bf16_f32 v22, v22, v22
    v_lshlrev_b32 v22, 16, v22
    v_rcp_f32 v22, v22
    s_nop 0
    v_mov_b32 v23, v22

    v_pk_mul_f32 v[96:97], v[96:97], v[22:23]
    v_pk_mul_f32 v[98:99], v[98:99], v[22:23]
    v_pk_mul_f32 v[100:101], v[100:101], v[22:23]
    v_pk_mul_f32 v[102:103], v[102:103], v[22:23]
    v_pk_mul_f32 v[104:105], v[104:105], v[22:23]
    v_pk_mul_f32 v[106:107], v[106:107], v[22:23]
    v_pk_mul_f32 v[108:109], v[108:109], v[22:23]
    v_pk_mul_f32 v[110:111], v[110:111], v[22:23]
    v_pk_mul_f32 v[112:113], v[112:113], v[22:23]
    v_pk_mul_f32 v[114:115], v[114:115], v[22:23]
    v_pk_mul_f32 v[116:117], v[116:117], v[22:23]
    v_pk_mul_f32 v[118:119], v[118:119], v[22:23]
    v_pk_mul_f32 v[120:121], v[120:121], v[22:23]
    v_pk_mul_f32 v[122:123], v[122:123], v[22:23]
    v_pk_mul_f32 v[124:125], v[124:125], v[22:23]
    v_pk_mul_f32 v[126:127], v[126:127], v[22:23]
    v_cvt_pk_bf16_f32 v64, v96, v97
    v_cvt_pk_bf16_f32 v65, v98, v99
    v_cvt_pk_bf16_f32 v66, v100, v101
    v_cvt_pk_bf16_f32 v67, v102, v103
    v_cvt_pk_bf16_f32 v68, v104, v105
    v_cvt_pk_bf16_f32 v69, v106, v107
    v_cvt_pk_bf16_f32 v70, v108, v109
    v_cvt_pk_bf16_f32 v71, v110, v111
    v_cvt_pk_bf16_f32 v72, v112, v113
    v_cvt_pk_bf16_f32 v73, v114, v115
    v_cvt_pk_bf16_f32 v74, v116, v117
    v_cvt_pk_bf16_f32 v75, v118, v119
    v_cvt_pk_bf16_f32 v76, v120, v121
    v_cvt_pk_bf16_f32 v77, v122, v123
    v_cvt_pk_bf16_f32 v78, v124, v125
    v_cvt_pk_bf16_f32 v79, v126, v127
    ds_write_b128 v16, v[64:67] offset:0
    ds_write_b128 v16, v[68:71] offset:256
    ds_write_b128 v16, v[72:75] offset:512
    ds_write_b128 v16, v[76:79] offset:768
    s_waitcnt vmcnt(10)
    v_lshlrev_b32 v96, 16, v80
    v_and_b32 v97, s33, v80
    v_lshlrev_b32 v98, 16, v81
    v_and_b32 v99, s33, v81
    v_lshlrev_b32 v100, 16, v82
    v_and_b32 v101, s33, v82
    v_lshlrev_b32 v102, 16, v83
    v_and_b32 v103, s33, v83
    v_lshlrev_b32 v104, 16, v84
    v_and_b32 v105, s33, v84
    v_lshlrev_b32 v106, 16, v85
    v_and_b32 v107, s33, v85
    v_lshlrev_b32 v108, 16, v86
    v_and_b32 v109, s33, v86
    v_lshlrev_b32 v110, 16, v87
    v_and_b32 v111, s33, v87
    v_lshlrev_b32 v112, 16, v88
    v_and_b32 v113, s33, v88
    v_lshlrev_b32 v114, 16, v89
    v_and_b32 v115, s33, v89
    v_lshlrev_b32 v116, 16, v90
    v_and_b32 v117, s33, v90
    v_lshlrev_b32 v118, 16, v91
    v_and_b32 v119, s33, v91
    v_lshlrev_b32 v120, 16, v92
    v_and_b32 v121, s33, v92
    v_lshlrev_b32 v122, 16, v93
    v_and_b32 v123, s33, v93
    v_lshlrev_b32 v124, 16, v94
    v_and_b32 v125, s33, v94
    v_lshlrev_b32 v126, 16, v95
    v_and_b32 v127, s33, v95
    v_pk_add_f32 v[20:21], v[96:97], v[98:99]
    v_pk_add_f32 v[22:23], v[100:101], v[102:103]
    v_pk_add_f32 v[20:21], v[20:21], v[104:105]
    v_pk_add_f32 v[20:21], v[20:21], v[106:107]
    v_pk_add_f32 v[22:23], v[22:23], v[108:109]
    v_pk_add_f32 v[22:23], v[22:23], v[110:111]
    v_pk_add_f32 v[20:21], v[20:21], v[112:113]
    v_pk_add_f32 v[20:21], v[20:21], v[114:115]
    v_pk_add_f32 v[22:23], v[22:23], v[116:117]
    v_pk_add_f32 v[22:23], v[22:23], v[118:119]
    v_pk_add_f32 v[20:21], v[20:21], v[120:121]
    v_pk_add_f32 v[20:21], v[20:21], v[122:123]
    v_pk_add_f32 v[22:23], v[22:23], v[124:125]
    v_pk_add_f32 v[22:23], v[22:23], v[126:127]
    v_pk_add_f32 v[20:21], v[20:21], v[22:23]
    v_add_f32 v20, v20, v21
    s_nop 1
    v_add_f32_dpp v20, v20, v20 row_ror:8 row_mask:0xf bank_mask:0xf
    s_nop 1
    v_add_f32_dpp v20, v20, v20 row_ror:4 row_mask:0xf bank_mask:0xf
    s_nop 1
    v_add_f32_dpp v20, v20, v20 row_ror:2 row_mask:0xf bank_mask:0xf
    s_nop 1
    v_add_f32_dpp v20, v20, v20 row_ror:1 row_mask:0xf bank_mask:0xf
    v_mul_f32 v20, s34, v20
    v_cvt_pk_bf16_f32 v21, v20, v20
    v_lshlrev_b32 v21, 16, v21
    v_sub_f32 v24, v20, v21

    v_pk_add_f32 v[96:97], v[96:97], v[20:21] op_sel:[0,1] op_sel_hi:[1,1] neg_lo:[0,1] neg_hi:[0,1]
    v_pk_add_f32 v[98:99], v[98:99], v[20:21] op_sel:[0,1] op_sel_hi:[1,1] neg_lo:[0,1] neg_hi:[0,1]
    v_pk_add_f32 v[100:101], v[100:101], v[20:21] op_sel:[0,1] op_sel_hi:[1,1] neg_lo:[0,1] neg_hi:[0,1]
    v_pk_add_f32 v[102:103], v[102:103], v[20:21] op_sel:[0,1] op_sel_hi:[1,1] neg_lo:[0,1] neg_hi:[0,1]
    v_pk_add_f32 v[104:105], v[104:105], v[20:21] op_sel:[0,1] op_sel_hi:[1,1] neg_lo:[0,1] neg_hi:[0,1]
    v_pk_add_f32 v[106:107], v[106:107], v[20:21] op_sel:[0,1] op_sel_hi:[1,1] neg_lo:[0,1] neg_hi:[0,1]
    v_pk_add_f32 v[108:109], v[108:109], v[20:21] op_sel:[0,1] op_sel_hi:[1,1] neg_lo:[0,1] neg_hi:[0,1]
    v_pk_add_f32 v[110:111], v[110:111], v[20:21] op_sel:[0,1] op_sel_hi:[1,1] neg_lo:[0,1] neg_hi:[0,1]
    v_pk_add_f32 v[112:113], v[112:113], v[20:21] op_sel:[0,1] op_sel_hi:[1,1] neg_lo:[0,1] neg_hi:[0,1]
    v_pk_add_f32 v[114:115], v[114:115], v[20:21] op_sel:[0,1] op_sel_hi:[1,1] neg_lo:[0,1] neg_hi:[0,1]
    v_pk_add_f32 v[116:117], v[116:117], v[20:21] op_sel:[0,1] op_sel_hi:[1,1] neg_lo:[0,1] neg_hi:[0,1]
    v_pk_add_f32 v[118:119], v[118:119], v[20:21] op_sel:[0,1] op_sel_hi:[1,1] neg_lo:[0,1] neg_hi:[0,1]
    v_pk_add_f32 v[120:121], v[120:121], v[20:21] op_sel:[0,1] op_sel_hi:[1,1] neg_lo:[0,1] neg_hi:[0,1]
    v_pk_add_f32 v[122:123], v[122:123], v[20:21] op_sel:[0,1] op_sel_hi:[1,1] neg_lo:[0,1] neg_hi:[0,1]
    v_pk_add_f32 v[124:125], v[124:125], v[20:21] op_sel:[0,1] op_sel_hi:[1,1] neg_lo:[0,1] neg_hi:[0,1]
    v_pk_add_f32 v[126:127], v[126:127], v[20:21] op_sel:[0,1] op_sel_hi:[1,1] neg_lo:[0,1] neg_hi:[0,1]
    v_pk_mul_f32 v[22:23], v[96:97], v[96:97]
    v_pk_mul_f32 v[26:27], v[98:99], v[98:99]
    v_pk_fma_f32 v[22:23], v[100:101], v[100:101], v[22:23]
    v_pk_fma_f32 v[26:27], v[102:103], v[102:103], v[26:27]
    v_pk_fma_f32 v[22:23], v[104:105], v[104:105], v[22:23]
    v_pk_fma_f32 v[26:27], v[106:107], v[106:107], v[26:27]
    v_pk_fma_f32 v[22:23], v[108:109], v[108:109], v[22:23]
    v_pk_fma_f32 v[26:27], v[110:111], v[110:111], v[26:27]
    v_pk_fma_f32 v[22:23], v[112:113], v[112:113], v[22:23]
    v_pk_fma_f32 v[26:27], v[114:115], v[114:115], v[26:27]
    v_pk_fma_f32 v[22:23], v[116:117], v[116:117], v[22:23]
    v_pk_fma_f32 v[26:27], v[118:119], v[118:119], v[26:27]
    v_pk_fma_f32 v[22:23], v[120:121], v[120:121], v[22:23]
    v_pk_fma_f32 v[26:27], v[122:123], v[122:123], v[26:27]
    v_pk_fma_f32 v[22:23], v[124:125], v[124:125], v[22:23]
    v_pk_fma_f32 v[26:27], v[126:127], v[126:127], v[26:27]
    v_pk_add_f32 v[22:23], v[22:23], v[26:27]
    v_add_f32 v22, v22, v23
    s_nop 1
    v_add_f32_dpp v22, v22, v22 row_ror:8 row_mask:0xf bank_mask:0xf
    s_nop 1
    v_add_f32_dpp v22, v22, v22 row_ror:4 row_mask:0xf bank_mask:0xf
    s_nop 1
    v_add_f32_dpp v22, v22, v22 row_ror:2 row_mask:0xf bank_mask:0xf
    s_nop 1
    v_add_f32_dpp v22, v22, v22 row_ror:1 row_mask:0xf bank_mask:0xf
    v_mul_f32 v22, s34, v22
    v_fma_f32 v22, -v24, v24, v22
    v_max_f32 v22, 0, v22
    v_cvt_pk_bf16_f32 v22, v22, v22
    v_lshlrev_b32 v22, 16, v22
    v_add_f32 v22, s35, v22
    v_cvt_pk_bf16_f32 v22, v22, v22
    v_lshlrev_b32 v22, 16, v22
    v_sqrt_f32 v22, v22
    s_nop 0
    v_cvt_pk_bf16_f32 v22, v22, v22
    v_lshlrev_b32 v22, 16, v22
    v_rcp_f32 v22, v22
    s_nop 0
    v_mov_b32 v23, v22

    v_pk_mul_f32 v[96:97], v[96:97], v[22:23]
    v_pk_mul_f32 v[98:99], v[98:99], v[22:23]
    v_pk_mul_f32 v[100:101], v[100:101], v[22:23]
    v_pk_mul_f32 v[102:103], v[102:103], v[22:23]
    v_pk_mul_f32 v[104:105], v[104:105], v[22:23]
    v_pk_mul_f32 v[106:107], v[106:107], v[22:23]
    v_pk_mul_f32 v[108:109], v[108:109], v[22:23]
    v_pk_mul_f32 v[110:111], v[110:111], v[22:23]
    v_pk_mul_f32 v[112:113], v[112:113], v[22:23]
    v_pk_mul_f32 v[114:115], v[114:115], v[22:23]
    v_pk_mul_f32 v[116:117], v[116:117], v[22:23]
    v_pk_mul_f32 v[118:119], v[118:119], v[22:23]
    v_pk_mul_f32 v[120:121], v[120:121], v[22:23]
    v_pk_mul_f32 v[122:123], v[122:123], v[22:23]
    v_pk_mul_f32 v[124:125], v[124:125], v[22:23]
    v_pk_mul_f32 v[126:127], v[126:127], v[22:23]
    v_cvt_pk_bf16_f32 v80, v96, v97
    v_cvt_pk_bf16_f32 v81, v98, v99
    v_cvt_pk_bf16_f32 v82, v100, v101
    v_cvt_pk_bf16_f32 v83, v102, v103
    v_cvt_pk_bf16_f32 v84, v104, v105
    v_cvt_pk_bf16_f32 v85, v106, v107
    v_cvt_pk_bf16_f32 v86, v108, v109
    v_cvt_pk_bf16_f32 v87, v110, v111
    v_cvt_pk_bf16_f32 v88, v112, v113
    v_cvt_pk_bf16_f32 v89, v114, v115
    v_cvt_pk_bf16_f32 v90, v116, v117
    v_cvt_pk_bf16_f32 v91, v118, v119
    v_cvt_pk_bf16_f32 v92, v120, v121
    v_cvt_pk_bf16_f32 v93, v122, v123
    v_cvt_pk_bf16_f32 v94, v124, v125
    v_cvt_pk_bf16_f32 v95, v126, v127
    ds_write_b128 v16, v[80:83] offset:4160
    ds_write_b128 v16, v[84:87] offset:4416
    ds_write_b128 v16, v[88:91] offset:4672
    ds_write_b128 v16, v[92:95] offset:4928
    s_waitcnt vmcnt(0)
    s_waitcnt lgkmcnt(0)
    s_barrier
    s_cmp_eq_u32 s18, 4
    s_cbranch_scc1 K1_KV
    s_cmp_gt_u32 s18, 4
    s_cbranch_scc1 K1_WO

    s_lshr_b32 s28, s18, 1
    s_lshl_b32 s28, s28, 5
    v_and_b32 v17, 31, v0
    v_add_u32 v17, s28, v17
    v_mul_lo_u32 v17, v17, s29
    v_lshrrev_b32 v18, 5, v0
    v_lshl_add_u32 v17, v18, 4, v17
    v_lshrrev_b32 v19, 2, v3
    v_lshl_add_u32 v18, v18, 3, v19
    v_and_b32 v20, 1, v2
    v_lshlrev_b32 v20, 5, v20
    v_and_b32 v21, 3, v3
    v_lshl_add_u32 v20, v21, 3, v20
    s_and_b32 s28, s18, 1
    s_lshl_b32 s28, s28, 6
    v_add_u32 v20, s28, v20
    v_lshrrev_b32 v21, 1, v19
    v_lshlrev_b32 v21, 6, v21
    v_xor_b32 v20, v20, v21
    v_lshl_add_u32 v18, v18, 7, v20
    v_add_u32 v18, 66560, v18

    ds_read_b64_tr_b16 v[64:65], v18 offset:0
    ds_read_b64_tr_b16 v[66:67], v18 offset:512
    ds_read_b128 v[68:71], v17 offset:0
    ds_read_b64_tr_b16 v[72:73], v18 offset:2048
    ds_read_b64_tr_b16 v[74:75], v18 offset:2560
    ds_read_b128 v[76:79], v17 offset:32
    ds_read_b64_tr_b16 v[80:81], v18 offset:4096
    ds_read_b64_tr_b16 v[82:83], v18 offset:4608
    ds_read_b128 v[84:87], v17 offset:64
    ds_read_b64_tr_b16 v[88:89], v18 offset:6144
    ds_read_b64_tr_b16 v[90:91], v18 offset:6656
    ds_read_b128 v[92:95], v17 offset:96
    s_waitcnt lgkmcnt(9)
    v_mfma_f32_32x32x16_bf16 v[32:47], v[64:67], v[68:71], 0
    ds_read_b64_tr_b16 v[64:65], v18 offset:8192
    ds_read_b64_tr_b16 v[66:67], v18 offset:8704
    ds_read_b128 v[68:71], v17 offset:128
    s_waitcnt lgkmcnt(9)
    v_mfma_f32_32x32x16_bf16 v[32:47], v[72:75], v[76:79], v[32:47]
    ds_read_b64_tr_b16 v[72:73], v18 offset:10240
    ds_read_b64_tr_b16 v[74:75], v18 offset:10752
    ds_read_b128 v[76:79], v17 offset:160
    s_waitcnt lgkmcnt(9)
    v_mfma_f32_32x32x16_bf16 v[32:47], v[80:83], v[84:87], v[32:47]
    ds_read_b64_tr_b16 v[80:81], v18 offset:12288
    ds_read_b64_tr_b16 v[82:83], v18 offset:12800
    ds_read_b128 v[84:87], v17 offset:192
    s_waitcnt lgkmcnt(9)
    v_mfma_f32_32x32x16_bf16 v[32:47], v[88:91], v[92:95], v[32:47]
    ds_read_b64_tr_b16 v[88:89], v18 offset:14336
    ds_read_b64_tr_b16 v[90:91], v18 offset:14848
    ds_read_b128 v[92:95], v17 offset:224
    s_waitcnt lgkmcnt(9)
    v_mfma_f32_32x32x16_bf16 v[32:47], v[64:67], v[68:71], v[32:47]
    ds_read_b64_tr_b16 v[64:65], v18 offset:16384
    ds_read_b64_tr_b16 v[66:67], v18 offset:16896
    ds_read_b128 v[68:71], v17 offset:256
    s_waitcnt lgkmcnt(9)
    v_mfma_f32_32x32x16_bf16 v[32:47], v[72:75], v[76:79], v[32:47]
    ds_read_b64_tr_b16 v[72:73], v18 offset:18432
    ds_read_b64_tr_b16 v[74:75], v18 offset:18944
    ds_read_b128 v[76:79], v17 offset:288
    s_waitcnt lgkmcnt(9)
    v_mfma_f32_32x32x16_bf16 v[32:47], v[80:83], v[84:87], v[32:47]
    ds_read_b64_tr_b16 v[80:81], v18 offset:20480
    ds_read_b64_tr_b16 v[82:83], v18 offset:20992
    ds_read_b128 v[84:87], v17 offset:320
    s_waitcnt lgkmcnt(9)
    v_mfma_f32_32x32x16_bf16 v[32:47], v[88:91], v[92:95], v[32:47]
    ds_read_b64_tr_b16 v[88:89], v18 offset:22528
    ds_read_b64_tr_b16 v[90:91], v18 offset:23040
    ds_read_b128 v[92:95], v17 offset:352
    s_waitcnt lgkmcnt(9)
    v_mfma_f32_32x32x16_bf16 v[32:47], v[64:67], v[68:71], v[32:47]
    ds_read_b64_tr_b16 v[64:65], v18 offset:24576
    ds_read_b64_tr_b16 v[66:67], v18 offset:25088
    ds_read_b128 v[68:71], v17 offset:384
    s_waitcnt lgkmcnt(9)
    v_mfma_f32_32x32x16_bf16 v[32:47], v[72:75], v[76:79], v[32:47]
    ds_read_b64_tr_b16 v[72:73], v18 offset:26624
    ds_read_b64_tr_b16 v[74:75], v18 offset:27136
    ds_read_b128 v[76:79], v17 offset:416
    s_waitcnt lgkmcnt(9)
    v_mfma_f32_32x32x16_bf16 v[32:47], v[80:83], v[84:87], v[32:47]
    ds_read_b64_tr_b16 v[80:81], v18 offset:28672
    ds_read_b64_tr_b16 v[82:83], v18 offset:29184
    ds_read_b128 v[84:87], v17 offset:448
    s_waitcnt lgkmcnt(9)
    v_mfma_f32_32x32x16_bf16 v[32:47], v[88:91], v[92:95], v[32:47]
    ds_read_b64_tr_b16 v[88:89], v18 offset:30720
    ds_read_b64_tr_b16 v[90:91], v18 offset:31232
    ds_read_b128 v[92:95], v17 offset:480
    s_waitcnt lgkmcnt(9)
    v_mfma_f32_32x32x16_bf16 v[32:47], v[64:67], v[68:71], v[32:47]
    ds_read_b64_tr_b16 v[64:65], v18 offset:32768
    ds_read_b64_tr_b16 v[66:67], v18 offset:33280
    ds_read_b128 v[68:71], v17 offset:512
    s_waitcnt lgkmcnt(9)
    v_mfma_f32_32x32x16_bf16 v[32:47], v[72:75], v[76:79], v[32:47]
    ds_read_b64_tr_b16 v[72:73], v18 offset:34816
    ds_read_b64_tr_b16 v[74:75], v18 offset:35328
    ds_read_b128 v[76:79], v17 offset:544
    s_waitcnt lgkmcnt(9)
    v_mfma_f32_32x32x16_bf16 v[32:47], v[80:83], v[84:87], v[32:47]
    ds_read_b64_tr_b16 v[80:81], v18 offset:36864
    ds_read_b64_tr_b16 v[82:83], v18 offset:37376
    ds_read_b128 v[84:87], v17 offset:576
    s_waitcnt lgkmcnt(9)
    v_mfma_f32_32x32x16_bf16 v[32:47], v[88:91], v[92:95], v[32:47]
    ds_read_b64_tr_b16 v[88:89], v18 offset:38912
    ds_read_b64_tr_b16 v[90:91], v18 offset:39424
    ds_read_b128 v[92:95], v17 offset:608
    s_waitcnt lgkmcnt(9)
    v_mfma_f32_32x32x16_bf16 v[32:47], v[64:67], v[68:71], v[32:47]
    ds_read_b64_tr_b16 v[64:65], v18 offset:40960
    ds_read_b64_tr_b16 v[66:67], v18 offset:41472
    ds_read_b128 v[68:71], v17 offset:640
    s_waitcnt lgkmcnt(9)
    v_mfma_f32_32x32x16_bf16 v[32:47], v[72:75], v[76:79], v[32:47]
    ds_read_b64_tr_b16 v[72:73], v18 offset:43008
    ds_read_b64_tr_b16 v[74:75], v18 offset:43520
    ds_read_b128 v[76:79], v17 offset:672
    s_waitcnt lgkmcnt(9)
    v_mfma_f32_32x32x16_bf16 v[32:47], v[80:83], v[84:87], v[32:47]
    ds_read_b64_tr_b16 v[80:81], v18 offset:45056
    ds_read_b64_tr_b16 v[82:83], v18 offset:45568
    ds_read_b128 v[84:87], v17 offset:704
    s_waitcnt lgkmcnt(9)
    v_mfma_f32_32x32x16_bf16 v[32:47], v[88:91], v[92:95], v[32:47]
    ds_read_b64_tr_b16 v[88:89], v18 offset:47104
    ds_read_b64_tr_b16 v[90:91], v18 offset:47616
    ds_read_b128 v[92:95], v17 offset:736
    s_waitcnt lgkmcnt(9)
    v_mfma_f32_32x32x16_bf16 v[32:47], v[64:67], v[68:71], v[32:47]
    ds_read_b64_tr_b16 v[64:65], v18 offset:49152
    ds_read_b64_tr_b16 v[66:67], v18 offset:49664
    ds_read_b128 v[68:71], v17 offset:768
    s_waitcnt lgkmcnt(9)
    v_mfma_f32_32x32x16_bf16 v[32:47], v[72:75], v[76:79], v[32:47]
    ds_read_b64_tr_b16 v[72:73], v18 offset:51200
    ds_read_b64_tr_b16 v[74:75], v18 offset:51712
    ds_read_b128 v[76:79], v17 offset:800
    s_waitcnt lgkmcnt(9)
    v_mfma_f32_32x32x16_bf16 v[32:47], v[80:83], v[84:87], v[32:47]
    ds_read_b64_tr_b16 v[80:81], v18 offset:53248
    ds_read_b64_tr_b16 v[82:83], v18 offset:53760
    ds_read_b128 v[84:87], v17 offset:832
    s_waitcnt lgkmcnt(9)
    v_mfma_f32_32x32x16_bf16 v[32:47], v[88:91], v[92:95], v[32:47]
    ds_read_b64_tr_b16 v[88:89], v18 offset:55296
    ds_read_b64_tr_b16 v[90:91], v18 offset:55808
    ds_read_b128 v[92:95], v17 offset:864
    s_waitcnt lgkmcnt(9)
    v_mfma_f32_32x32x16_bf16 v[32:47], v[64:67], v[68:71], v[32:47]
    ds_read_b64_tr_b16 v[64:65], v18 offset:57344
    ds_read_b64_tr_b16 v[66:67], v18 offset:57856
    ds_read_b128 v[68:71], v17 offset:896
    s_waitcnt lgkmcnt(9)
    v_mfma_f32_32x32x16_bf16 v[32:47], v[72:75], v[76:79], v[32:47]
    ds_read_b64_tr_b16 v[72:73], v18 offset:59392
    ds_read_b64_tr_b16 v[74:75], v18 offset:59904
    ds_read_b128 v[76:79], v17 offset:928
    s_waitcnt lgkmcnt(9)
    v_mfma_f32_32x32x16_bf16 v[32:47], v[80:83], v[84:87], v[32:47]
    ds_read_b64_tr_b16 v[80:81], v18 offset:61440
    ds_read_b64_tr_b16 v[82:83], v18 offset:61952
    ds_read_b128 v[84:87], v17 offset:960
    s_waitcnt lgkmcnt(9)
    v_mfma_f32_32x32x16_bf16 v[32:47], v[88:91], v[92:95], v[32:47]
    ds_read_b64_tr_b16 v[88:89], v18 offset:63488
    ds_read_b64_tr_b16 v[90:91], v18 offset:64000
    ds_read_b128 v[92:95], v17 offset:992
    s_waitcnt lgkmcnt(9)
    v_mfma_f32_32x32x16_bf16 v[32:47], v[64:67], v[68:71], v[32:47]
    s_waitcnt lgkmcnt(6)
    v_mfma_f32_32x32x16_bf16 v[32:47], v[72:75], v[76:79], v[32:47]
    s_waitcnt lgkmcnt(3)
    v_mfma_f32_32x32x16_bf16 v[32:47], v[80:83], v[84:87], v[32:47]
    s_waitcnt lgkmcnt(0)
    v_mfma_f32_32x32x16_bf16 v[32:47], v[88:91], v[92:95], v[32:47]
    s_lshl_b32 s28, s16, 6
    s_lshr_b32 s30, s18, 1
    s_lshl_b32 s30, s30, 5
    s_add_u32 s28, s28, s30
    v_and_b32 v20, 31, v0
    v_add_u32 v20, s28, v20
    v_lshlrev_b32 v20, 10, v20
    v_lshrrev_b32 v21, 5, v0
    v_lshl_add_u32 v20, v21, 3, v20
    s_lshl_b32 s28, s17, 7
    s_and_b32 s30, s18, 1
    s_lshl_b32 s30, s30, 6
    s_add_u32 s28, s28, s30
    v_add_u32 v20, s28, v20
    s_mov_b32 s31, 1052289595
    s_nop 2

    v_mul_f32 v32, s31, v32
    v_mul_f32 v33, s31, v33
    v_mul_f32 v34, s31, v34
    v_mul_f32 v35, s31, v35
    v_mul_f32 v36, s31, v36
    v_mul_f32 v37, s31, v37
    v_mul_f32 v38, s31, v38
    v_mul_f32 v39, s31, v39
    v_mul_f32 v40, s31, v40
    v_mul_f32 v41, s31, v41
    v_mul_f32 v42, s31, v42
    v_mul_f32 v43, s31, v43
    v_mul_f32 v44, s31, v44
    v_mul_f32 v45, s31, v45
    v_mul_f32 v46, s31, v46
    v_mul_f32 v47, s31, v47
    v_cvt_pk_bf16_f32 v56, v32, v33
    v_cvt_pk_bf16_f32 v57, v34, v35
    v_cvt_pk_bf16_f32 v58, v36, v37
    v_cvt_pk_bf16_f32 v59, v38, v39
    v_cvt_pk_bf16_f32 v60, v40, v41
    v_cvt_pk_bf16_f32 v61, v42, v43
    v_cvt_pk_bf16_f32 v62, v44, v45
    v_cvt_pk_bf16_f32 v63, v46, v47
    global_store_dwordx2 v20, v[56:57], s[14:15] offset:0
    global_store_dwordx2 v20, v[58:59], s[14:15] offset:16
    global_store_dwordx2 v20, v[60:61], s[14:15] offset:32
    global_store_dwordx2 v20, v[62:63], s[14:15] offset:48
    s_branch K1_FIN
K1_WO:
    s_cmp_eq_u32 s18, 7
    s_cbranch_scc1 K1_FIN
    s_sub_u32 s31, s18, 5
    s_lshl_b32 s30, s2, 1
    s_add_u32 s30, s30, s31
    s_lshr_b32 s31, s30, 4
    s_and_b32 s32, s30, 15
    s_lshl_b32 s32, s32, 15
    s_lshl_b32 s31, s31, 5
    s_add_u32 s31, s31, s32
    v_lshlrev_b32 v10, 13, v2
    v_lshl_add_u32 v10, v3, 1, v10
    v_add_u32 v10, s31, v10
    v_add_u32 v10, 4096, v10
    s_lshl_b32 s30, s30, 10
    s_add_u32 s30, s30, 2228224
    v_add_u32 v11, s30, v9

    global_load_ushort v48, v10, s[12:13] offset:-4096
    global_load_ushort v49, v10, s[12:13] offset:-3072
    global_load_ushort v50, v10, s[12:13] offset:-2048
    global_load_ushort v51, v10, s[12:13] offset:-1024
    global_load_ushort v52, v10, s[12:13] offset:0
    global_load_ushort v53, v10, s[12:13] offset:1024
    global_load_ushort v54, v10, s[12:13] offset:2048
    global_load_ushort v55, v10, s[12:13] offset:3072
    s_waitcnt vmcnt(0)
    v_lshl_or_b32 v12, v49, 16, v48
    v_lshl_or_b32 v13, v51, 16, v50
    v_lshl_or_b32 v14, v53, 16, v52
    v_lshl_or_b32 v15, v55, 16, v54
    global_store_dwordx4 v11, v[12:15], s[14:15]
    s_branch K1_FIN

K1_KV:
    s_and_b32 s28, s17, 3
    s_lshl_b32 s28, s28, 4
    v_add_u32 v17, s28, v3
    v_mul_lo_u32 v17, v17, s29
    v_lshl_add_u32 v17, v2, 4, v17
    v_lshrrev_b32 v19, 2, v3
    v_lshl_add_u32 v18, v2, 3, v19
    v_lshlrev_b32 v18, 5, v18
    v_and_b32 v21, 3, v3
    v_lshl_add_u32 v18, v21, 3, v18
    v_add_u32 v18, 132096, v18

    s_cmp_ge_u32 s17, 4
    s_cbranch_scc1 K1_V
    ds_read_b64_tr_b16 v[64:65], v18 offset:0
    ds_read_b64_tr_b16 v[66:67], v18 offset:128
    ds_read_b128 v[68:71], v17 offset:0
    ds_read_b64_tr_b16 v[72:73], v18 offset:1024
    ds_read_b64_tr_b16 v[74:75], v18 offset:1152
    ds_read_b128 v[76:79], v17 offset:64
    ds_read_b64_tr_b16 v[80:81], v18 offset:2048
    ds_read_b64_tr_b16 v[82:83], v18 offset:2176
    ds_read_b128 v[84:87], v17 offset:128
    ds_read_b64_tr_b16 v[88:89], v18 offset:3072
    ds_read_b64_tr_b16 v[90:91], v18 offset:3200
    ds_read_b128 v[92:95], v17 offset:192
    s_waitcnt lgkmcnt(9)
    v_mfma_f32_16x16x32_bf16 v[32:35], v[64:67], v[68:71], 0
    ds_read_b64_tr_b16 v[64:65], v18 offset:4096
    ds_read_b64_tr_b16 v[66:67], v18 offset:4224
    ds_read_b128 v[68:71], v17 offset:256
    s_waitcnt lgkmcnt(9)
    v_mfma_f32_16x16x32_bf16 v[32:35], v[72:75], v[76:79], v[32:35]
    ds_read_b64_tr_b16 v[72:73], v18 offset:5120
    ds_read_b64_tr_b16 v[74:75], v18 offset:5248
    ds_read_b128 v[76:79], v17 offset:320
    s_waitcnt lgkmcnt(9)
    v_mfma_f32_16x16x32_bf16 v[32:35], v[80:83], v[84:87], v[32:35]
    ds_read_b64_tr_b16 v[80:81], v18 offset:6144
    ds_read_b64_tr_b16 v[82:83], v18 offset:6272
    ds_read_b128 v[84:87], v17 offset:384
    s_waitcnt lgkmcnt(9)
    v_mfma_f32_16x16x32_bf16 v[32:35], v[88:91], v[92:95], v[32:35]
    ds_read_b64_tr_b16 v[88:89], v18 offset:7168
    ds_read_b64_tr_b16 v[90:91], v18 offset:7296
    ds_read_b128 v[92:95], v17 offset:448
    s_waitcnt lgkmcnt(9)
    v_mfma_f32_16x16x32_bf16 v[32:35], v[64:67], v[68:71], v[32:35]
    ds_read_b64_tr_b16 v[64:65], v18 offset:8192
    ds_read_b64_tr_b16 v[66:67], v18 offset:8320
    ds_read_b128 v[68:71], v17 offset:512
    s_waitcnt lgkmcnt(9)
    v_mfma_f32_16x16x32_bf16 v[32:35], v[72:75], v[76:79], v[32:35]
    ds_read_b64_tr_b16 v[72:73], v18 offset:9216
    ds_read_b64_tr_b16 v[74:75], v18 offset:9344
    ds_read_b128 v[76:79], v17 offset:576
    s_waitcnt lgkmcnt(9)
    v_mfma_f32_16x16x32_bf16 v[32:35], v[80:83], v[84:87], v[32:35]
    ds_read_b64_tr_b16 v[80:81], v18 offset:10240
    ds_read_b64_tr_b16 v[82:83], v18 offset:10368
    ds_read_b128 v[84:87], v17 offset:640
    s_waitcnt lgkmcnt(9)
    v_mfma_f32_16x16x32_bf16 v[32:35], v[88:91], v[92:95], v[32:35]
    ds_read_b64_tr_b16 v[88:89], v18 offset:11264
    ds_read_b64_tr_b16 v[90:91], v18 offset:11392
    ds_read_b128 v[92:95], v17 offset:704
    s_waitcnt lgkmcnt(9)
    v_mfma_f32_16x16x32_bf16 v[32:35], v[64:67], v[68:71], v[32:35]
    ds_read_b64_tr_b16 v[64:65], v18 offset:12288
    ds_read_b64_tr_b16 v[66:67], v18 offset:12416
    ds_read_b128 v[68:71], v17 offset:768
    s_waitcnt lgkmcnt(9)
    v_mfma_f32_16x16x32_bf16 v[32:35], v[72:75], v[76:79], v[32:35]
    ds_read_b64_tr_b16 v[72:73], v18 offset:13312
    ds_read_b64_tr_b16 v[74:75], v18 offset:13440
    ds_read_b128 v[76:79], v17 offset:832
    s_waitcnt lgkmcnt(9)
    v_mfma_f32_16x16x32_bf16 v[32:35], v[80:83], v[84:87], v[32:35]
    ds_read_b64_tr_b16 v[80:81], v18 offset:14336
    ds_read_b64_tr_b16 v[82:83], v18 offset:14464
    ds_read_b128 v[84:87], v17 offset:896
    s_waitcnt lgkmcnt(9)
    v_mfma_f32_16x16x32_bf16 v[32:35], v[88:91], v[92:95], v[32:35]
    ds_read_b64_tr_b16 v[88:89], v18 offset:15360
    ds_read_b64_tr_b16 v[90:91], v18 offset:15488
    ds_read_b128 v[92:95], v17 offset:960
    s_waitcnt lgkmcnt(9)
    v_mfma_f32_16x16x32_bf16 v[32:35], v[64:67], v[68:71], v[32:35]
    s_waitcnt lgkmcnt(6)
    v_mfma_f32_16x16x32_bf16 v[32:35], v[72:75], v[76:79], v[32:35]
    s_waitcnt lgkmcnt(3)
    v_mfma_f32_16x16x32_bf16 v[32:35], v[80:83], v[84:87], v[32:35]
    s_waitcnt lgkmcnt(0)
    v_mfma_f32_16x16x32_bf16 v[32:35], v[88:91], v[92:95], v[32:35]
    s_lshl_b32 s30, s16, 6
    s_add_u32 s30, s30, s28
    v_add_u32 v20, s30, v3
    v_lshrrev_b32 v21, 5, v20
    v_lshlrev_b32 v21, 10, v21
    v_and_b32 v20, 31, v20
    v_lshl_add_u32 v20, v20, 4, v21
    v_lshrrev_b32 v21, 1, v2
    v_lshl_add_u32 v20, v21, 9, v20
    v_and_b32 v21, 1, v2
    v_lshl_add_u32 v20, v21, 3, v20
    v_add_u32 v20, 2097152, v20

    s_nop 4
    v_cvt_pk_bf16_f32 v36, v32, v33
    v_cvt_pk_bf16_f32 v37, v34, v35
    global_store_dwordx2 v20, v[36:37], s[14:15]
    s_branch K1_FIN

K1_V:
    ds_read_b64_tr_b16 v[64:65], v18 offset:0
    ds_read_b64_tr_b16 v[66:67], v18 offset:128
    ds_read_b128 v[68:71], v17 offset:0
    ds_read_b64_tr_b16 v[72:73], v18 offset:1024
    ds_read_b64_tr_b16 v[74:75], v18 offset:1152
    ds_read_b128 v[76:79], v17 offset:64
    ds_read_b64_tr_b16 v[80:81], v18 offset:2048
    ds_read_b64_tr_b16 v[82:83], v18 offset:2176
    ds_read_b128 v[84:87], v17 offset:128
    ds_read_b64_tr_b16 v[88:89], v18 offset:3072
    ds_read_b64_tr_b16 v[90:91], v18 offset:3200
    ds_read_b128 v[92:95], v17 offset:192
    s_waitcnt lgkmcnt(9)
    v_mfma_f32_16x16x32_bf16 v[32:35], v[68:71], v[64:67], 0
    ds_read_b64_tr_b16 v[64:65], v18 offset:4096
    ds_read_b64_tr_b16 v[66:67], v18 offset:4224
    ds_read_b128 v[68:71], v17 offset:256
    s_waitcnt lgkmcnt(9)
    v_mfma_f32_16x16x32_bf16 v[32:35], v[76:79], v[72:75], v[32:35]
    ds_read_b64_tr_b16 v[72:73], v18 offset:5120
    ds_read_b64_tr_b16 v[74:75], v18 offset:5248
    ds_read_b128 v[76:79], v17 offset:320
    s_waitcnt lgkmcnt(9)
    v_mfma_f32_16x16x32_bf16 v[32:35], v[84:87], v[80:83], v[32:35]
    ds_read_b64_tr_b16 v[80:81], v18 offset:6144
    ds_read_b64_tr_b16 v[82:83], v18 offset:6272
    ds_read_b128 v[84:87], v17 offset:384
    s_waitcnt lgkmcnt(9)
    v_mfma_f32_16x16x32_bf16 v[32:35], v[92:95], v[88:91], v[32:35]
    ds_read_b64_tr_b16 v[88:89], v18 offset:7168
    ds_read_b64_tr_b16 v[90:91], v18 offset:7296
    ds_read_b128 v[92:95], v17 offset:448
    s_waitcnt lgkmcnt(9)
    v_mfma_f32_16x16x32_bf16 v[32:35], v[68:71], v[64:67], v[32:35]
    ds_read_b64_tr_b16 v[64:65], v18 offset:8192
    ds_read_b64_tr_b16 v[66:67], v18 offset:8320
    ds_read_b128 v[68:71], v17 offset:512
    s_waitcnt lgkmcnt(9)
    v_mfma_f32_16x16x32_bf16 v[32:35], v[76:79], v[72:75], v[32:35]
    ds_read_b64_tr_b16 v[72:73], v18 offset:9216
    ds_read_b64_tr_b16 v[74:75], v18 offset:9344
    ds_read_b128 v[76:79], v17 offset:576
    s_waitcnt lgkmcnt(9)
    v_mfma_f32_16x16x32_bf16 v[32:35], v[84:87], v[80:83], v[32:35]
    ds_read_b64_tr_b16 v[80:81], v18 offset:10240
    ds_read_b64_tr_b16 v[82:83], v18 offset:10368
    ds_read_b128 v[84:87], v17 offset:640
    s_waitcnt lgkmcnt(9)
    v_mfma_f32_16x16x32_bf16 v[32:35], v[92:95], v[88:91], v[32:35]
    ds_read_b64_tr_b16 v[88:89], v18 offset:11264
    ds_read_b64_tr_b16 v[90:91], v18 offset:11392
    ds_read_b128 v[92:95], v17 offset:704
    s_waitcnt lgkmcnt(9)
    v_mfma_f32_16x16x32_bf16 v[32:35], v[68:71], v[64:67], v[32:35]
    ds_read_b64_tr_b16 v[64:65], v18 offset:12288
    ds_read_b64_tr_b16 v[66:67], v18 offset:12416
    ds_read_b128 v[68:71], v17 offset:768
    s_waitcnt lgkmcnt(9)
    v_mfma_f32_16x16x32_bf16 v[32:35], v[76:79], v[72:75], v[32:35]
    ds_read_b64_tr_b16 v[72:73], v18 offset:13312
    ds_read_b64_tr_b16 v[74:75], v18 offset:13440
    ds_read_b128 v[76:79], v17 offset:832
    s_waitcnt lgkmcnt(9)
    v_mfma_f32_16x16x32_bf16 v[32:35], v[84:87], v[80:83], v[32:35]
    ds_read_b64_tr_b16 v[80:81], v18 offset:14336
    ds_read_b64_tr_b16 v[82:83], v18 offset:14464
    ds_read_b128 v[84:87], v17 offset:896
    s_waitcnt lgkmcnt(9)
    v_mfma_f32_16x16x32_bf16 v[32:35], v[92:95], v[88:91], v[32:35]
    ds_read_b64_tr_b16 v[88:89], v18 offset:15360
    ds_read_b64_tr_b16 v[90:91], v18 offset:15488
    ds_read_b128 v[92:95], v17 offset:960
    s_waitcnt lgkmcnt(9)
    v_mfma_f32_16x16x32_bf16 v[32:35], v[68:71], v[64:67], v[32:35]
    s_waitcnt lgkmcnt(6)
    v_mfma_f32_16x16x32_bf16 v[32:35], v[76:79], v[72:75], v[32:35]
    s_waitcnt lgkmcnt(3)
    v_mfma_f32_16x16x32_bf16 v[32:35], v[84:87], v[80:83], v[32:35]
    s_waitcnt lgkmcnt(0)
    v_mfma_f32_16x16x32_bf16 v[32:35], v[92:95], v[88:91], v[32:35]
    s_lshl_b32 s30, s16, 2
    s_and_b32 s31, s17, 3
    s_add_u32 s30, s30, s31
    s_lshl_b32 s30, s30, 9
    s_add_u32 s30, s30, 2162688
    v_lshlrev_b32 v20, 4, v3
    v_and_b32 v21, 1, v2
    v_lshl_add_u32 v20, v21, 8, v20
    v_lshrrev_b32 v21, 1, v2
    v_lshl_add_u32 v20, v21, 3, v20
    v_add_u32 v20, s30, v20

    s_nop 4
    v_cvt_pk_bf16_f32 v36, v32, v33
    v_cvt_pk_bf16_f32 v37, v34, v35
    global_store_dwordx2 v20, v[36:37], s[14:15]
    s_branch K1_FIN

K1_FIN:
K1_END:
    s_endpgm
.globl k2_attn_kernel
.p2align 8
.type k2_attn_kernel,@function
k2_attn_kernel:
    s_cmp_ge_u32 s2, 256
    s_cbranch_scc1 K2_END
    s_load_dwordx2 s[4:5], s[0:1], 0
    s_load_dwordx4 s[8:11], s[0:1], 48
    s_load_dwordx2 s[12:13], s[0:1], 64
    s_load_dwordx2 s[14:15], s[0:1], 88
    v_lshrrev_b32 v1, 6, v0
    v_and_b32 v0, 63, v0
    s_and_b32 s16, s2, 7
    s_lshl_b32 s16, s16, 5
    s_lshr_b32 s17, s2, 3
    s_add_u32 s16, s16, s17
    s_lshl_b32 s16, s16, 3
    v_readfirstlane_b32 s18, v1
    s_mov_b32 s40, 0
    s_waitcnt lgkmcnt(0)

    s_add_u32 s20, s14, 2097152
    s_addc_u32 s21, s15, 0
    s_mov_b32 s22, 131072
    s_mov_b32 s23, 0x00020000
    v_and_b32 v2, 7, v0
    v_bfe_u32 v3, v0, 3, 2
    v_lshrrev_b32 v8, 5, v0
    v_add_u32 v9, s16, v2
    v_lshlrev_b32 v9, 10, v9
    v_lshl_add_u32 v9, v3, 5, v9
    v_lshl_add_u32 v9, v8, 4, v9
    s_lshl_b32 s19, s18, 7
    v_add_u32 v9, s19, v9
    global_load_dwordx4 v[4:7], v9, s[14:15]
    v_lshlrev_b32 v112, 4, v0

    s_lshl_b32 s48, s18, 11
    s_add_u32 s29, s48, 0
    s_mov_b32 m0, s29
    s_nop 0
    buffer_load_dwordx4 v112, s[20:23], s29 offen lds
    s_add_u32 s29, s48, 1024
    s_mov_b32 m0, s29
    s_nop 0
    buffer_load_dwordx4 v112, s[20:23], s29 offen lds
    s_add_u32 s29, s48, 65536
    s_mov_b32 m0, s29
    s_nop 0
    buffer_load_dwordx4 v112, s[20:23], s29 offen lds
    s_add_u32 s29, s48, 66560
    s_mov_b32 m0, s29
    s_nop 0
    buffer_load_dwordx4 v112, s[20:23], s29 offen lds
    v_and_b32 v10, 15, v0
    v_lshlrev_b32 v10, 4, v10
    v_lshl_add_u32 v113, v8, 8, v10
    v_add_u32 v113, 65536, v113
    v_and_b32 v10, 27, v0
    v_and_b32 v10, 31, v10
    v_cmp_eq_u32 vcc, 16, v10
    v_mov_b32 v11, 0x3f803f80
    s_mov_b32 s42, 0xffff
    s_mov_b32 s43, 0xffff
    s_nop 1
    v_cndmask_b32 v11, 0, v11, vcc

    v_mov_b32 v96, v11
    v_mov_b32 v97, v11
    v_mov_b32 v98, v11
    v_mov_b32 v99, v11
    v_mov_b32 v100, v11
    v_mov_b32 v101, v11
    v_mov_b32 v102, v11
    v_mov_b32 v103, v11
    v_mov_b32 v104, v11
    v_mov_b32 v105, v11
    v_mov_b32 v106, v11
    v_mov_b32 v107, v11
    v_mov_b32 v108, v11
    v_mov_b32 v109, v11
    v_mov_b32 v110, v11
    v_mov_b32 v111, v11
    v_mov_b32 v9, 157824
    v_mov_b32 v10, 0
    ds_write_b32 v9, v10
    s_waitcnt vmcnt(0) lgkmcnt(0)
    s_barrier
    ds_read_b128 v[88:91], v112
    s_waitcnt lgkmcnt(0)
    v_mfma_f32_32x32x16_bf16 v[32:47], v[88:91], v[4:7], 0
    s_nop 15
    v_max3_f32 v10, v32, v33, v34

    v_max3_f32 v10, v10, v35, v36
    v_max3_f32 v10, v10, v37, v38
    v_max3_f32 v10, v10, v39, v40
    v_max3_f32 v10, v10, v41, v42
    v_max3_f32 v10, v10, v43, v44
    v_max3_f32 v10, v10, v45, v46
    v_max_f32 v10, v10, v47
    v_mov_b32 v11, v10
    s_nop 1
    v_permlane32_swap_b32 v10, v11
    s_mov_b32 s44, 1109393408
    v_max_f32 v10, v10, v11
    v_add_f32 v10, s44, v10
    v_sub_f32 v10, 0, v10

    s_cmp_lt_u32 s18, 4
    s_cbranch_scc1 K2_NOPRIO
    s_setprio 1
    K2_NOPRIO:

K2_RESTART:
    v_mov_b32 v16, v10
    v_mov_b32 v17, v10
    v_mov_b32 v18, v10
    v_mov_b32 v19, v10
    v_mov_b32 v20, v10
    v_mov_b32 v21, v10
    v_mov_b32 v22, v10
    v_mov_b32 v23, v10
    v_mov_b32 v24, v10
    v_mov_b32 v25, v10
    v_mov_b32 v26, v10
    v_mov_b32 v27, v10
    v_mov_b32 v28, v10
    v_mov_b32 v29, v10
    v_mov_b32 v30, v10
    v_mov_b32 v31, v10
    ds_read_b128 v[88:91], v112
    ds_read_b128 v[92:95], v112 offset:1024
    s_mov_b64 exec, s[42:43]
    ds_read_b128 v[96:99], v113
    ds_read_b128 v[100:103], v113 offset:512
    s_mov_b64 exec, -1
    s_lshl_b32 s28, s18, 16
    s_add_u32 s28, s28, 2232320
    v_add_u32 v114, s28, v112
    v_add_u32 v115, 16384, v114
    v_add_u32 v116, 32768, v114
    v_add_u32 v117, 49152, v114
    s_lshl_b32 s28, s2, 3
    s_add_u32 s28, s28, s18
    s_mov_b32 s78, s28
    s_min_u32 s28, s28, 1791
    s_bfe_u32 s29, s28, 0x10001
    s_lshl_b32 s29, s29, 2
    v_and_b32 v10, 7, v0
    v_xor_b32 v10, s29, v10
    v_lshrrev_b32 v9, 3, v0
    s_mov_b32 s29, 229376
    v_mul_lo_u32 v119, v9, s29
    v_lshl_add_u32 v119, v10, 4, v119
    s_lshl_b32 s29, s28, 7
    s_add_u32 s29, s29, 15728640
    v_add_u32 v119, s29, v119
    s_lshl_b32 s28, s28, 10
    v_add_u32 v14, s28, v112
    s_waitcnt lgkmcnt(0)
    v_mfma_f32_32x32x16_bf16 v[32:47], v[88:91], v[4:7], v[16:31]
    s_nop 7

    v_mfma_f32_32x32x16_bf16 v[48:63], v[92:95], v[4:7], v[16:31]
    ds_read_b128 v[88:91], v112 offset:2048
    v_exp_f32 v32, v32
    v_exp_f32 v33, v33
    v_exp_f32 v34, v34
    v_exp_f32 v35, v35
    v_exp_f32 v36, v36
    s_mov_b64 exec, s[42:43]
    ds_read_b128 v[104:107], v113 offset:1024
    ds_read_b128 v[108:111], v113 offset:1536
    s_mov_b64 exec, -1
    v_exp_f32 v37, v37
    v_exp_f32 v38, v38
    v_exp_f32 v39, v39
    v_cvt_pk_bf16_f32 v64, v32, v33
    v_cvt_pk_bf16_f32 v65, v34, v35
    v_cvt_pk_bf16_f32 v66, v36, v37
    v_cvt_pk_bf16_f32 v67, v38, v39
    v_exp_f32 v40, v40
    v_exp_f32 v41, v41
    v_mfma_f32_32x32x16_bf16 v[72:87], v[96:99], v[64:67], 0
    v_exp_f32 v42, v42
    v_exp_f32 v43, v43
    v_exp_f32 v44, v44
    s_add_u32 s29, s48, 16384
    s_mov_b32 m0, s29
    s_nop 0
    buffer_load_dwordx4 v112, s[20:23], s29 offen lds
    v_exp_f32 v45, v45
    v_exp_f32 v46, v46
    v_exp_f32 v47, v47
    v_cvt_pk_bf16_f32 v68, v40, v41
    v_cvt_pk_bf16_f32 v69, v42, v43
    v_cvt_pk_bf16_f32 v70, v44, v45
    v_cvt_pk_bf16_f32 v71, v46, v47
    s_waitcnt lgkmcnt(0)
    v_mfma_f32_32x32x16_bf16 v[32:47], v[88:91], v[4:7], v[16:31]
    ds_read_b128 v[92:95], v112 offset:3072
    v_exp_f32 v48, v48
    v_exp_f32 v49, v49
    v_exp_f32 v50, v50
    v_exp_f32 v51, v51
    v_exp_f32 v52, v52
    v_mfma_f32_32x32x16_bf16 v[72:87], v[100:103], v[68:71], v[72:87]
    s_mov_b64 exec, s[42:43]
    ds_read_b128 v[96:99], v113 offset:2048
    ds_read_b128 v[100:103], v113 offset:2560
    s_mov_b64 exec, -1
    v_exp_f32 v53, v53
    v_exp_f32 v54, v54
    v_exp_f32 v55, v55
    v_cvt_pk_bf16_f32 v120, v48, v49
    v_cvt_pk_bf16_f32 v121, v50, v51
    v_cvt_pk_bf16_f32 v122, v52, v53
    v_cvt_pk_bf16_f32 v123, v54, v55
    v_exp_f32 v56, v56
    v_exp_f32 v57, v57
    v_mfma_f32_32x32x16_bf16 v[72:87], v[104:107], v[120:123], v[72:87]
    v_exp_f32 v58, v58
    v_exp_f32 v59, v59
    v_exp_f32 v60, v60
    s_add_u32 s29, s48, 17408
    s_mov_b32 m0, s29
    s_nop 0
    buffer_load_dwordx4 v112, s[20:23], s29 offen lds
    v_exp_f32 v61, v61
    v_exp_f32 v62, v62
    v_exp_f32 v63, v63
    v_cvt_pk_bf16_f32 v124, v56, v57
    v_cvt_pk_bf16_f32 v125, v58, v59
    v_cvt_pk_bf16_f32 v126, v60, v61
    v_cvt_pk_bf16_f32 v127, v62, v63
    s_waitcnt lgkmcnt(0)
    v_mfma_f32_32x32x16_bf16 v[48:63], v[92:95], v[4:7], v[16:31]
    ds_read_b128 v[88:91], v112 offset:4096
    v_exp_f32 v32, v32
    v_exp_f32 v33, v33
    v_exp_f32 v34, v34
    v_exp_f32 v35, v35
    v_exp_f32 v36, v36
    v_mfma_f32_32x32x16_bf16 v[72:87], v[108:111], v[124:127], v[72:87]
    s_mov_b64 exec, s[42:43]
    ds_read_b128 v[104:107], v113 offset:3072
    ds_read_b128 v[108:111], v113 offset:3584
    s_mov_b64 exec, -1
    v_exp_f32 v37, v37
    v_exp_f32 v38, v38
    v_exp_f32 v39, v39
    v_cvt_pk_bf16_f32 v64, v32, v33
    v_cvt_pk_bf16_f32 v65, v34, v35
    v_cvt_pk_bf16_f32 v66, v36, v37
    v_cvt_pk_bf16_f32 v67, v38, v39
    v_exp_f32 v40, v40
    v_exp_f32 v41, v41
    v_mfma_f32_32x32x16_bf16 v[72:87], v[96:99], v[64:67], v[72:87]
    v_exp_f32 v42, v42
    v_exp_f32 v43, v43
    v_exp_f32 v44, v44
    s_add_u32 s29, s48, 81920
    s_mov_b32 m0, s29
    s_nop 0
    buffer_load_dwordx4 v112, s[20:23], s29 offen lds
    v_exp_f32 v45, v45
    v_exp_f32 v46, v46
    v_exp_f32 v47, v47
    v_cvt_pk_bf16_f32 v68, v40, v41
    v_cvt_pk_bf16_f32 v69, v42, v43
    v_cvt_pk_bf16_f32 v70, v44, v45
    v_cvt_pk_bf16_f32 v71, v46, v47
    s_waitcnt lgkmcnt(0)
    v_mfma_f32_32x32x16_bf16 v[32:47], v[88:91], v[4:7], v[16:31]
    ds_read_b128 v[92:95], v112 offset:5120
    v_exp_f32 v48, v48
    v_exp_f32 v49, v49
    v_exp_f32 v50, v50
    v_exp_f32 v51, v51
    v_exp_f32 v52, v52
    v_mfma_f32_32x32x16_bf16 v[72:87], v[100:103], v[68:71], v[72:87]
    s_mov_b64 exec, s[42:43]
    ds_read_b128 v[96:99], v113 offset:4096
    ds_read_b128 v[100:103], v113 offset:4608
    s_mov_b64 exec, -1
    v_exp_f32 v53, v53
    v_exp_f32 v54, v54
    v_exp_f32 v55, v55
    v_cvt_pk_bf16_f32 v120, v48, v49
    v_cvt_pk_bf16_f32 v121, v50, v51
    v_cvt_pk_bf16_f32 v122, v52, v53
    v_cvt_pk_bf16_f32 v123, v54, v55
    v_exp_f32 v56, v56
    v_exp_f32 v57, v57
    v_mfma_f32_32x32x16_bf16 v[72:87], v[104:107], v[120:123], v[72:87]
    v_exp_f32 v58, v58
    v_exp_f32 v59, v59
    v_exp_f32 v60, v60
    s_add_u32 s29, s48, 82944
    s_mov_b32 m0, s29
    s_nop 0
    buffer_load_dwordx4 v112, s[20:23], s29 offen lds
    v_exp_f32 v61, v61
    v_exp_f32 v62, v62
    v_exp_f32 v63, v63
    v_cvt_pk_bf16_f32 v124, v56, v57
    v_cvt_pk_bf16_f32 v125, v58, v59
    v_cvt_pk_bf16_f32 v126, v60, v61
    v_cvt_pk_bf16_f32 v127, v62, v63
    s_waitcnt lgkmcnt(0)
    v_mfma_f32_32x32x16_bf16 v[48:63], v[92:95], v[4:7], v[16:31]
    ds_read_b128 v[88:91], v112 offset:6144
    v_exp_f32 v32, v32
    v_exp_f32 v33, v33
    v_exp_f32 v34, v34
    v_exp_f32 v35, v35
    v_exp_f32 v36, v36
    v_mfma_f32_32x32x16_bf16 v[72:87], v[108:111], v[124:127], v[72:87]
    s_mov_b64 exec, s[42:43]
    ds_read_b128 v[104:107], v113 offset:5120
    ds_read_b128 v[108:111], v113 offset:5632
    s_mov_b64 exec, -1
    v_exp_f32 v37, v37
    v_exp_f32 v38, v38
    v_exp_f32 v39, v39
    v_cvt_pk_bf16_f32 v64, v32, v33
    v_cvt_pk_bf16_f32 v65, v34, v35
    v_cvt_pk_bf16_f32 v66, v36, v37
    v_cvt_pk_bf16_f32 v67, v38, v39
    v_exp_f32 v40, v40
    v_exp_f32 v41, v41
    v_mfma_f32_32x32x16_bf16 v[72:87], v[96:99], v[64:67], v[72:87]
    v_exp_f32 v42, v42
    v_exp_f32 v43, v43
    v_exp_f32 v44, v44
    s_add_u32 s29, s48, 32768
    s_mov_b32 m0, s29
    s_nop 0
    buffer_load_dwordx4 v112, s[20:23], s29 offen lds
    v_exp_f32 v45, v45
    v_exp_f32 v46, v46
    v_exp_f32 v47, v47
    v_cvt_pk_bf16_f32 v68, v40, v41
    v_cvt_pk_bf16_f32 v69, v42, v43
    v_cvt_pk_bf16_f32 v70, v44, v45
    v_cvt_pk_bf16_f32 v71, v46, v47
    s_waitcnt lgkmcnt(0)
    v_mfma_f32_32x32x16_bf16 v[32:47], v[88:91], v[4:7], v[16:31]
    ds_read_b128 v[92:95], v112 offset:7168
    v_exp_f32 v48, v48
    v_exp_f32 v49, v49
    v_exp_f32 v50, v50
    v_exp_f32 v51, v51
    v_exp_f32 v52, v52
    v_mfma_f32_32x32x16_bf16 v[72:87], v[100:103], v[68:71], v[72:87]
    s_mov_b64 exec, s[42:43]
    ds_read_b128 v[96:99], v113 offset:6144
    ds_read_b128 v[100:103], v113 offset:6656
    s_mov_b64 exec, -1
    v_exp_f32 v53, v53
    v_exp_f32 v54, v54
    v_exp_f32 v55, v55
    v_cvt_pk_bf16_f32 v120, v48, v49
    v_cvt_pk_bf16_f32 v121, v50, v51
    v_cvt_pk_bf16_f32 v122, v52, v53
    v_cvt_pk_bf16_f32 v123, v54, v55
    v_exp_f32 v56, v56
    v_exp_f32 v57, v57
    v_mfma_f32_32x32x16_bf16 v[72:87], v[104:107], v[120:123], v[72:87]
    v_exp_f32 v58, v58
    v_exp_f32 v59, v59
    v_exp_f32 v60, v60
    s_add_u32 s29, s48, 33792
    s_mov_b32 m0, s29
    s_nop 0
    buffer_load_dwordx4 v112, s[20:23], s29 offen lds
    v_exp_f32 v61, v61
    v_exp_f32 v62, v62
    v_exp_f32 v63, v63
    v_cvt_pk_bf16_f32 v124, v56, v57
    v_cvt_pk_bf16_f32 v125, v58, v59
    v_cvt_pk_bf16_f32 v126, v60, v61
    v_cvt_pk_bf16_f32 v127, v62, v63
    s_waitcnt lgkmcnt(0)
    v_mfma_f32_32x32x16_bf16 v[48:63], v[92:95], v[4:7], v[16:31]
    ds_read_b128 v[88:91], v112 offset:8192
    v_exp_f32 v32, v32
    v_exp_f32 v33, v33
    v_exp_f32 v34, v34
    v_exp_f32 v35, v35
    v_exp_f32 v36, v36
    v_mfma_f32_32x32x16_bf16 v[72:87], v[108:111], v[124:127], v[72:87]
    s_mov_b64 exec, s[42:43]
    ds_read_b128 v[104:107], v113 offset:7168
    ds_read_b128 v[108:111], v113 offset:7680
    s_mov_b64 exec, -1
    v_exp_f32 v37, v37
    v_exp_f32 v38, v38
    v_exp_f32 v39, v39
    v_cvt_pk_bf16_f32 v64, v32, v33
    v_cvt_pk_bf16_f32 v65, v34, v35
    v_cvt_pk_bf16_f32 v66, v36, v37
    v_cvt_pk_bf16_f32 v67, v38, v39
    v_exp_f32 v40, v40
    v_exp_f32 v41, v41
    v_mfma_f32_32x32x16_bf16 v[72:87], v[96:99], v[64:67], v[72:87]
    v_exp_f32 v42, v42
    v_exp_f32 v43, v43
    v_exp_f32 v44, v44
    s_add_u32 s29, s48, 98304
    s_mov_b32 m0, s29
    s_nop 0
    buffer_load_dwordx4 v112, s[20:23], s29 offen lds
    v_exp_f32 v45, v45
    v_exp_f32 v46, v46
    v_exp_f32 v47, v47
    v_cvt_pk_bf16_f32 v68, v40, v41
    v_cvt_pk_bf16_f32 v69, v42, v43
    v_cvt_pk_bf16_f32 v70, v44, v45
    v_cvt_pk_bf16_f32 v71, v46, v47
    s_waitcnt lgkmcnt(0)
    v_mfma_f32_32x32x16_bf16 v[32:47], v[88:91], v[4:7], v[16:31]
    ds_read_b128 v[92:95], v112 offset:9216
    v_exp_f32 v48, v48
    v_exp_f32 v49, v49
    v_exp_f32 v50, v50
    v_exp_f32 v51, v51
    v_exp_f32 v52, v52
    v_mfma_f32_32x32x16_bf16 v[72:87], v[100:103], v[68:71], v[72:87]
    s_mov_b64 exec, s[42:43]
    ds_read_b128 v[96:99], v113 offset:8192
    ds_read_b128 v[100:103], v113 offset:8704
    s_mov_b64 exec, -1
    v_exp_f32 v53, v53
    v_exp_f32 v54, v54
    v_exp_f32 v55, v55
    v_cvt_pk_bf16_f32 v120, v48, v49
    v_cvt_pk_bf16_f32 v121, v50, v51
    v_cvt_pk_bf16_f32 v122, v52, v53
    v_cvt_pk_bf16_f32 v123, v54, v55
    v_exp_f32 v56, v56
    v_exp_f32 v57, v57
    v_mfma_f32_32x32x16_bf16 v[72:87], v[104:107], v[120:123], v[72:87]
    v_exp_f32 v58, v58
    v_exp_f32 v59, v59
    v_exp_f32 v60, v60
    s_add_u32 s29, s48, 99328
    s_mov_b32 m0, s29
    s_nop 0
    buffer_load_dwordx4 v112, s[20:23], s29 offen lds
    v_exp_f32 v61, v61
    v_exp_f32 v62, v62
    v_exp_f32 v63, v63
    v_cvt_pk_bf16_f32 v124, v56, v57
    v_cvt_pk_bf16_f32 v125, v58, v59
    v_cvt_pk_bf16_f32 v126, v60, v61
    v_cvt_pk_bf16_f32 v127, v62, v63
    s_waitcnt lgkmcnt(0)
    v_mfma_f32_32x32x16_bf16 v[48:63], v[92:95], v[4:7], v[16:31]
    ds_read_b128 v[88:91], v112 offset:10240
    v_exp_f32 v32, v32
    v_exp_f32 v33, v33
    v_exp_f32 v34, v34
    v_exp_f32 v35, v35
    v_exp_f32 v36, v36
    v_mfma_f32_32x32x16_bf16 v[72:87], v[108:111], v[124:127], v[72:87]
    s_mov_b64 exec, s[42:43]
    ds_read_b128 v[104:107], v113 offset:9216
    ds_read_b128 v[108:111], v113 offset:9728
    s_mov_b64 exec, -1
    v_exp_f32 v37, v37
    v_exp_f32 v38, v38
    v_exp_f32 v39, v39
    v_cvt_pk_bf16_f32 v64, v32, v33
    v_cvt_pk_bf16_f32 v65, v34, v35
    v_cvt_pk_bf16_f32 v66, v36, v37
    v_cvt_pk_bf16_f32 v67, v38, v39
    v_exp_f32 v40, v40
    v_exp_f32 v41, v41
    v_mfma_f32_32x32x16_bf16 v[72:87], v[96:99], v[64:67], v[72:87]
    v_exp_f32 v42, v42
    v_exp_f32 v43, v43
    v_exp_f32 v44, v44
    s_add_u32 s29, s48, 49152
    s_mov_b32 m0, s29
    s_nop 0
    buffer_load_dwordx4 v112, s[20:23], s29 offen lds
    v_exp_f32 v45, v45
    v_exp_f32 v46, v46
    v_exp_f32 v47, v47
    v_cvt_pk_bf16_f32 v68, v40, v41
    v_cvt_pk_bf16_f32 v69, v42, v43
    v_cvt_pk_bf16_f32 v70, v44, v45
    v_cvt_pk_bf16_f32 v71, v46, v47
    s_waitcnt lgkmcnt(0)
    v_mfma_f32_32x32x16_bf16 v[32:47], v[88:91], v[4:7], v[16:31]
    ds_read_b128 v[92:95], v112 offset:11264
    v_exp_f32 v48, v48
    v_exp_f32 v49, v49
    v_exp_f32 v50, v50
    v_exp_f32 v51, v51
    v_exp_f32 v52, v52
    v_mfma_f32_32x32x16_bf16 v[72:87], v[100:103], v[68:71], v[72:87]
    s_mov_b64 exec, s[42:43]
    ds_read_b128 v[96:99], v113 offset:10240
    ds_read_b128 v[100:103], v113 offset:10752
    s_mov_b64 exec, -1
    v_exp_f32 v53, v53
    v_exp_f32 v54, v54
    v_exp_f32 v55, v55
    v_cvt_pk_bf16_f32 v120, v48, v49
    v_cvt_pk_bf16_f32 v121, v50, v51
    v_cvt_pk_bf16_f32 v122, v52, v53
    v_cvt_pk_bf16_f32 v123, v54, v55
    v_exp_f32 v56, v56
    v_exp_f32 v57, v57
    v_mfma_f32_32x32x16_bf16 v[72:87], v[104:107], v[120:123], v[72:87]
    v_exp_f32 v58, v58
    v_exp_f32 v59, v59
    v_exp_f32 v60, v60
    s_add_u32 s29, s48, 50176
    s_mov_b32 m0, s29
    s_nop 0
    buffer_load_dwordx4 v112, s[20:23], s29 offen lds
    v_exp_f32 v61, v61
    v_exp_f32 v62, v62
    v_exp_f32 v63, v63
    v_cvt_pk_bf16_f32 v124, v56, v57
    v_cvt_pk_bf16_f32 v125, v58, v59
    v_cvt_pk_bf16_f32 v126, v60, v61
    v_cvt_pk_bf16_f32 v127, v62, v63
    s_waitcnt lgkmcnt(0)
    v_mfma_f32_32x32x16_bf16 v[48:63], v[92:95], v[4:7], v[16:31]
    ds_read_b128 v[88:91], v112 offset:12288
    v_exp_f32 v32, v32
    v_exp_f32 v33, v33
    v_exp_f32 v34, v34
    v_exp_f32 v35, v35
    v_exp_f32 v36, v36
    v_mfma_f32_32x32x16_bf16 v[72:87], v[108:111], v[124:127], v[72:87]
    s_mov_b64 exec, s[42:43]
    ds_read_b128 v[104:107], v113 offset:11264
    ds_read_b128 v[108:111], v113 offset:11776
    s_mov_b64 exec, -1
    v_exp_f32 v37, v37
    v_exp_f32 v38, v38
    v_exp_f32 v39, v39
    v_cvt_pk_bf16_f32 v64, v32, v33
    v_cvt_pk_bf16_f32 v65, v34, v35
    v_cvt_pk_bf16_f32 v66, v36, v37
    v_cvt_pk_bf16_f32 v67, v38, v39
    v_exp_f32 v40, v40
    v_exp_f32 v41, v41
    v_mfma_f32_32x32x16_bf16 v[72:87], v[96:99], v[64:67], v[72:87]
    v_exp_f32 v42, v42
    v_exp_f32 v43, v43
    v_exp_f32 v44, v44
    s_add_u32 s29, s48, 114688
    s_mov_b32 m0, s29
    s_nop 0
    buffer_load_dwordx4 v112, s[20:23], s29 offen lds
    v_exp_f32 v45, v45
    v_exp_f32 v46, v46
    v_exp_f32 v47, v47
    v_cvt_pk_bf16_f32 v68, v40, v41
    v_cvt_pk_bf16_f32 v69, v42, v43
    v_cvt_pk_bf16_f32 v70, v44, v45
    v_cvt_pk_bf16_f32 v71, v46, v47
    s_waitcnt lgkmcnt(0)
    v_mfma_f32_32x32x16_bf16 v[32:47], v[88:91], v[4:7], v[16:31]
    ds_read_b128 v[92:95], v112 offset:13312
    v_exp_f32 v48, v48
    v_exp_f32 v49, v49
    v_exp_f32 v50, v50
    v_exp_f32 v51, v51
    v_exp_f32 v52, v52
    v_mfma_f32_32x32x16_bf16 v[72:87], v[100:103], v[68:71], v[72:87]
    s_mov_b64 exec, s[42:43]
    ds_read_b128 v[96:99], v113 offset:12288
    ds_read_b128 v[100:103], v113 offset:12800
    s_mov_b64 exec, -1
    v_exp_f32 v53, v53
    v_exp_f32 v54, v54
    v_exp_f32 v55, v55
    v_cvt_pk_bf16_f32 v120, v48, v49
    v_cvt_pk_bf16_f32 v121, v50, v51
    v_cvt_pk_bf16_f32 v122, v52, v53
    v_cvt_pk_bf16_f32 v123, v54, v55
    v_exp_f32 v56, v56
    v_exp_f32 v57, v57
    v_mfma_f32_32x32x16_bf16 v[72:87], v[104:107], v[120:123], v[72:87]
    v_exp_f32 v58, v58
    v_exp_f32 v59, v59
    v_exp_f32 v60, v60
    s_add_u32 s29, s48, 115712
    s_mov_b32 m0, s29
    s_nop 0
    buffer_load_dwordx4 v112, s[20:23], s29 offen lds
    v_exp_f32 v61, v61
    v_exp_f32 v62, v62
    v_exp_f32 v63, v63
    v_cvt_pk_bf16_f32 v124, v56, v57
    v_cvt_pk_bf16_f32 v125, v58, v59
    v_cvt_pk_bf16_f32 v126, v60, v61
    v_cvt_pk_bf16_f32 v127, v62, v63
    s_waitcnt lgkmcnt(0)
    v_mfma_f32_32x32x16_bf16 v[48:63], v[92:95], v[4:7], v[16:31]
    ds_read_b128 v[88:91], v112 offset:14336
    v_exp_f32 v32, v32
    v_exp_f32 v33, v33
    v_exp_f32 v34, v34
    v_exp_f32 v35, v35
    v_exp_f32 v36, v36
    v_mfma_f32_32x32x16_bf16 v[72:87], v[108:111], v[124:127], v[72:87]
    s_mov_b64 exec, s[42:43]
    ds_read_b128 v[104:107], v113 offset:13312
    ds_read_b128 v[108:111], v113 offset:13824
    s_mov_b64 exec, -1
    v_exp_f32 v37, v37
    v_exp_f32 v38, v38
    v_exp_f32 v39, v39
    v_cvt_pk_bf16_f32 v64, v32, v33
    v_cvt_pk_bf16_f32 v65, v34, v35
    v_cvt_pk_bf16_f32 v66, v36, v37
    v_cvt_pk_bf16_f32 v67, v38, v39
    v_exp_f32 v40, v40
    v_exp_f32 v41, v41
    v_mfma_f32_32x32x16_bf16 v[72:87], v[96:99], v[64:67], v[72:87]
    v_exp_f32 v42, v42
    v_exp_f32 v43, v43
    v_exp_f32 v44, v44
    v_exp_f32 v45, v45
    v_exp_f32 v46, v46
    v_exp_f32 v47, v47
    v_cvt_pk_bf16_f32 v68, v40, v41
    v_cvt_pk_bf16_f32 v69, v42, v43
    v_cvt_pk_bf16_f32 v70, v44, v45
    v_cvt_pk_bf16_f32 v71, v46, v47
    s_waitcnt lgkmcnt(0)
    v_mfma_f32_32x32x16_bf16 v[32:47], v[88:91], v[4:7], v[16:31]
    ds_read_b128 v[92:95], v112 offset:15360
    v_exp_f32 v48, v48
    v_exp_f32 v49, v49
    v_exp_f32 v50, v50
    v_exp_f32 v51, v51
    v_exp_f32 v52, v52
    v_mfma_f32_32x32x16_bf16 v[72:87], v[100:103], v[68:71], v[72:87]
    s_mov_b64 exec, s[42:43]
    ds_read_b128 v[96:99], v113 offset:14336
    ds_read_b128 v[100:103], v113 offset:14848
    s_mov_b64 exec, -1
    v_exp_f32 v53, v53
    v_exp_f32 v54, v54
    v_exp_f32 v55, v55
    v_cvt_pk_bf16_f32 v120, v48, v49
    v_cvt_pk_bf16_f32 v121, v50, v51
    v_cvt_pk_bf16_f32 v122, v52, v53
    v_cvt_pk_bf16_f32 v123, v54, v55
    v_exp_f32 v56, v56
    v_exp_f32 v57, v57
    v_mfma_f32_32x32x16_bf16 v[72:87], v[104:107], v[120:123], v[72:87]
    v_exp_f32 v58, v58
    v_exp_f32 v59, v59
    v_exp_f32 v60, v60
    v_exp_f32 v61, v61
    v_exp_f32 v62, v62
    v_exp_f32 v63, v63
    v_cvt_pk_bf16_f32 v124, v56, v57
    v_cvt_pk_bf16_f32 v125, v58, v59
    v_cvt_pk_bf16_f32 v126, v60, v61
    v_cvt_pk_bf16_f32 v127, v62, v63
    s_waitcnt lgkmcnt(0)
    s_cmp_lg_u32 s40, 0
    s_cbranch_scc1 K2_SKIPBAR
    s_waitcnt vmcnt(0)
    s_barrier
    K2_SKIPBAR:

    v_mfma_f32_32x32x16_bf16 v[48:63], v[92:95], v[4:7], v[16:31]
    ds_read_b128 v[88:91], v112 offset:16384
    v_exp_f32 v32, v32
    v_exp_f32 v33, v33
    v_exp_f32 v34, v34
    v_exp_f32 v35, v35
    v_exp_f32 v36, v36
    v_mfma_f32_32x32x16_bf16 v[72:87], v[108:111], v[124:127], v[72:87]
    s_mov_b64 exec, s[42:43]
    ds_read_b128 v[104:107], v113 offset:15360
    ds_read_b128 v[108:111], v113 offset:15872
    s_mov_b64 exec, -1
    v_exp_f32 v37, v37
    v_exp_f32 v38, v38
    v_exp_f32 v39, v39
    v_cvt_pk_bf16_f32 v64, v32, v33
    v_cvt_pk_bf16_f32 v65, v34, v35
    v_cvt_pk_bf16_f32 v66, v36, v37
    v_cvt_pk_bf16_f32 v67, v38, v39
    v_exp_f32 v40, v40
    v_exp_f32 v41, v41
    v_mfma_f32_32x32x16_bf16 v[72:87], v[96:99], v[64:67], v[72:87]
    v_exp_f32 v42, v42
    v_exp_f32 v43, v43
    v_exp_f32 v44, v44
    v_exp_f32 v45, v45
    v_exp_f32 v46, v46
    v_exp_f32 v47, v47
    v_cvt_pk_bf16_f32 v68, v40, v41
    v_cvt_pk_bf16_f32 v69, v42, v43
    v_cvt_pk_bf16_f32 v70, v44, v45
    v_cvt_pk_bf16_f32 v71, v46, v47
    s_waitcnt lgkmcnt(0)
    v_mfma_f32_32x32x16_bf16 v[32:47], v[88:91], v[4:7], v[16:31]
    ds_read_b128 v[92:95], v112 offset:17408
    v_exp_f32 v48, v48
    v_exp_f32 v49, v49
    v_exp_f32 v50, v50
    v_exp_f32 v51, v51
    v_exp_f32 v52, v52
    v_mfma_f32_32x32x16_bf16 v[72:87], v[100:103], v[68:71], v[72:87]
    s_mov_b64 exec, s[42:43]
    ds_read_b128 v[96:99], v113 offset:16384
    ds_read_b128 v[100:103], v113 offset:16896
    s_mov_b64 exec, -1
    v_exp_f32 v53, v53
    v_exp_f32 v54, v54
    v_exp_f32 v55, v55
    v_cvt_pk_bf16_f32 v120, v48, v49
    v_cvt_pk_bf16_f32 v121, v50, v51
    v_cvt_pk_bf16_f32 v122, v52, v53
    v_cvt_pk_bf16_f32 v123, v54, v55
    v_exp_f32 v56, v56
    v_exp_f32 v57, v57
    v_mfma_f32_32x32x16_bf16 v[72:87], v[104:107], v[120:123], v[72:87]
    v_exp_f32 v58, v58
    v_exp_f32 v59, v59
    v_exp_f32 v60, v60
    v_exp_f32 v61, v61
    v_exp_f32 v62, v62
    v_exp_f32 v63, v63
    v_cvt_pk_bf16_f32 v124, v56, v57
    v_cvt_pk_bf16_f32 v125, v58, v59
    v_cvt_pk_bf16_f32 v126, v60, v61
    v_cvt_pk_bf16_f32 v127, v62, v63
    s_waitcnt lgkmcnt(0)
    v_mfma_f32_32x32x16_bf16 v[48:63], v[92:95], v[4:7], v[16:31]
    ds_read_b128 v[88:91], v112 offset:18432
    v_exp_f32 v32, v32
    v_exp_f32 v33, v33
    v_exp_f32 v34, v34
    v_exp_f32 v35, v35
    v_exp_f32 v36, v36
    v_mfma_f32_32x32x16_bf16 v[72:87], v[108:111], v[124:127], v[72:87]
    s_mov_b64 exec, s[42:43]
    ds_read_b128 v[104:107], v113 offset:17408
    ds_read_b128 v[108:111], v113 offset:17920
    s_mov_b64 exec, -1
    v_exp_f32 v37, v37
    v_exp_f32 v38, v38
    v_exp_f32 v39, v39
    v_cvt_pk_bf16_f32 v64, v32, v33
    v_cvt_pk_bf16_f32 v65, v34, v35
    v_cvt_pk_bf16_f32 v66, v36, v37
    v_cvt_pk_bf16_f32 v67, v38, v39
    v_exp_f32 v40, v40
    v_exp_f32 v41, v41
    v_mfma_f32_32x32x16_bf16 v[72:87], v[96:99], v[64:67], v[72:87]
    v_exp_f32 v42, v42
    v_exp_f32 v43, v43
    v_exp_f32 v44, v44
    global_load_dwordx4 v[132:135], v14, s[12:13]
    v_exp_f32 v45, v45
    v_exp_f32 v46, v46
    v_exp_f32 v47, v47
    v_cvt_pk_bf16_f32 v68, v40, v41
    v_cvt_pk_bf16_f32 v69, v42, v43
    v_cvt_pk_bf16_f32 v70, v44, v45
    v_cvt_pk_bf16_f32 v71, v46, v47
    s_waitcnt lgkmcnt(0)
    v_mfma_f32_32x32x16_bf16 v[32:47], v[88:91], v[4:7], v[16:31]
    ds_read_b128 v[92:95], v112 offset:19456
    v_exp_f32 v48, v48
    v_exp_f32 v49, v49
    v_exp_f32 v50, v50
    v_exp_f32 v51, v51
    v_exp_f32 v52, v52
    v_mfma_f32_32x32x16_bf16 v[72:87], v[100:103], v[68:71], v[72:87]
    s_mov_b64 exec, s[42:43]
    ds_read_b128 v[96:99], v113 offset:18432
    ds_read_b128 v[100:103], v113 offset:18944
    s_mov_b64 exec, -1
    v_exp_f32 v53, v53
    v_exp_f32 v54, v54
    v_exp_f32 v55, v55
    v_cvt_pk_bf16_f32 v120, v48, v49
    v_cvt_pk_bf16_f32 v121, v50, v51
    v_cvt_pk_bf16_f32 v122, v52, v53
    v_cvt_pk_bf16_f32 v123, v54, v55
    v_exp_f32 v56, v56
    v_exp_f32 v57, v57
    v_mfma_f32_32x32x16_bf16 v[72:87], v[104:107], v[120:123], v[72:87]
    v_exp_f32 v58, v58
    v_exp_f32 v59, v59
    v_exp_f32 v60, v60
    global_load_dwordx4 v[128:131], v14, s[8:9]
    v_exp_f32 v61, v61
    v_exp_f32 v62, v62
    v_exp_f32 v63, v63
    v_cvt_pk_bf16_f32 v124, v56, v57
    v_cvt_pk_bf16_f32 v125, v58, v59
    v_cvt_pk_bf16_f32 v126, v60, v61
    v_cvt_pk_bf16_f32 v127, v62, v63
    s_waitcnt lgkmcnt(0)
    v_mfma_f32_32x32x16_bf16 v[48:63], v[92:95], v[4:7], v[16:31]
    ds_read_b128 v[88:91], v112 offset:20480
    v_exp_f32 v32, v32
    v_exp_f32 v33, v33
    v_exp_f32 v34, v34
    v_exp_f32 v35, v35
    v_exp_f32 v36, v36
    v_mfma_f32_32x32x16_bf16 v[72:87], v[108:111], v[124:127], v[72:87]
    s_mov_b64 exec, s[42:43]
    ds_read_b128 v[104:107], v113 offset:19456
    ds_read_b128 v[108:111], v113 offset:19968
    s_mov_b64 exec, -1
    v_exp_f32 v37, v37
    v_exp_f32 v38, v38
    v_exp_f32 v39, v39
    v_cvt_pk_bf16_f32 v64, v32, v33
    v_cvt_pk_bf16_f32 v65, v34, v35
    v_cvt_pk_bf16_f32 v66, v36, v37
    v_cvt_pk_bf16_f32 v67, v38, v39
    v_exp_f32 v40, v40
    v_exp_f32 v41, v41
    v_mfma_f32_32x32x16_bf16 v[72:87], v[96:99], v[64:67], v[72:87]
    v_exp_f32 v42, v42
    v_exp_f32 v43, v43
    v_exp_f32 v44, v44
    global_load_dwordx4 v[128:131], v14, s[10:11]
    v_exp_f32 v45, v45
    v_exp_f32 v46, v46
    v_exp_f32 v47, v47
    v_cvt_pk_bf16_f32 v68, v40, v41
    v_cvt_pk_bf16_f32 v69, v42, v43
    v_cvt_pk_bf16_f32 v70, v44, v45
    v_cvt_pk_bf16_f32 v71, v46, v47
    s_waitcnt lgkmcnt(0)
    v_mfma_f32_32x32x16_bf16 v[32:47], v[88:91], v[4:7], v[16:31]
    ds_read_b128 v[92:95], v112 offset:21504
    v_exp_f32 v48, v48
    v_exp_f32 v49, v49
    v_exp_f32 v50, v50
    v_exp_f32 v51, v51
    v_exp_f32 v52, v52
    v_mfma_f32_32x32x16_bf16 v[72:87], v[100:103], v[68:71], v[72:87]
    s_mov_b64 exec, s[42:43]
    ds_read_b128 v[96:99], v113 offset:20480
    ds_read_b128 v[100:103], v113 offset:20992
    s_mov_b64 exec, -1
    v_exp_f32 v53, v53
    v_exp_f32 v54, v54
    v_exp_f32 v55, v55
    v_cvt_pk_bf16_f32 v120, v48, v49
    v_cvt_pk_bf16_f32 v121, v50, v51
    v_cvt_pk_bf16_f32 v122, v52, v53
    v_cvt_pk_bf16_f32 v123, v54, v55
    v_exp_f32 v56, v56
    v_exp_f32 v57, v57
    v_mfma_f32_32x32x16_bf16 v[72:87], v[104:107], v[120:123], v[72:87]
    v_exp_f32 v58, v58
    v_exp_f32 v59, v59
    v_exp_f32 v60, v60
    v_exp_f32 v61, v61
    v_exp_f32 v62, v62
    v_exp_f32 v63, v63
    v_cvt_pk_bf16_f32 v124, v56, v57
    v_cvt_pk_bf16_f32 v125, v58, v59
    v_cvt_pk_bf16_f32 v126, v60, v61
    v_cvt_pk_bf16_f32 v127, v62, v63
    s_waitcnt lgkmcnt(0)
    v_mfma_f32_32x32x16_bf16 v[48:63], v[92:95], v[4:7], v[16:31]
    ds_read_b128 v[88:91], v112 offset:22528
    v_exp_f32 v32, v32
    v_exp_f32 v33, v33
    v_exp_f32 v34, v34
    v_exp_f32 v35, v35
    v_exp_f32 v36, v36
    v_mfma_f32_32x32x16_bf16 v[72:87], v[108:111], v[124:127], v[72:87]
    s_mov_b64 exec, s[42:43]
    ds_read_b128 v[104:107], v113 offset:21504
    ds_read_b128 v[108:111], v113 offset:22016
    s_mov_b64 exec, -1
    v_exp_f32 v37, v37
    v_exp_f32 v38, v38
    v_exp_f32 v39, v39
    v_cvt_pk_bf16_f32 v64, v32, v33
    v_cvt_pk_bf16_f32 v65, v34, v35
    v_cvt_pk_bf16_f32 v66, v36, v37
    v_cvt_pk_bf16_f32 v67, v38, v39
    v_exp_f32 v40, v40
    v_exp_f32 v41, v41
    v_mfma_f32_32x32x16_bf16 v[72:87], v[96:99], v[64:67], v[72:87]
    v_exp_f32 v42, v42
    v_exp_f32 v43, v43
    v_exp_f32 v44, v44
    v_exp_f32 v45, v45
    v_exp_f32 v46, v46
    v_exp_f32 v47, v47
    v_cvt_pk_bf16_f32 v68, v40, v41
    v_cvt_pk_bf16_f32 v69, v42, v43
    v_cvt_pk_bf16_f32 v70, v44, v45
    v_cvt_pk_bf16_f32 v71, v46, v47
    s_waitcnt lgkmcnt(0)
    v_mfma_f32_32x32x16_bf16 v[32:47], v[88:91], v[4:7], v[16:31]
    ds_read_b128 v[92:95], v112 offset:23552
    v_exp_f32 v48, v48
    v_exp_f32 v49, v49
    v_exp_f32 v50, v50
    v_exp_f32 v51, v51
    v_exp_f32 v52, v52
    v_mfma_f32_32x32x16_bf16 v[72:87], v[100:103], v[68:71], v[72:87]
    s_mov_b64 exec, s[42:43]
    ds_read_b128 v[96:99], v113 offset:22528
    ds_read_b128 v[100:103], v113 offset:23040
    s_mov_b64 exec, -1
    v_exp_f32 v53, v53
    v_exp_f32 v54, v54
    v_exp_f32 v55, v55
    v_cvt_pk_bf16_f32 v120, v48, v49
    v_cvt_pk_bf16_f32 v121, v50, v51
    v_cvt_pk_bf16_f32 v122, v52, v53
    v_cvt_pk_bf16_f32 v123, v54, v55
    v_exp_f32 v56, v56
    v_exp_f32 v57, v57
    v_mfma_f32_32x32x16_bf16 v[72:87], v[104:107], v[120:123], v[72:87]
    v_exp_f32 v58, v58
    v_exp_f32 v59, v59
    v_exp_f32 v60, v60
    v_exp_f32 v61, v61
    v_exp_f32 v62, v62
    v_exp_f32 v63, v63
    v_cvt_pk_bf16_f32 v124, v56, v57
    v_cvt_pk_bf16_f32 v125, v58, v59
    v_cvt_pk_bf16_f32 v126, v60, v61
    v_cvt_pk_bf16_f32 v127, v62, v63
    s_waitcnt lgkmcnt(0)
    v_mfma_f32_32x32x16_bf16 v[48:63], v[92:95], v[4:7], v[16:31]
    ds_read_b128 v[88:91], v112 offset:24576
    v_exp_f32 v32, v32
    v_exp_f32 v33, v33
    v_exp_f32 v34, v34
    v_exp_f32 v35, v35
    v_exp_f32 v36, v36
    v_mfma_f32_32x32x16_bf16 v[72:87], v[108:111], v[124:127], v[72:87]
    s_mov_b64 exec, s[42:43]
    ds_read_b128 v[104:107], v113 offset:23552
    ds_read_b128 v[108:111], v113 offset:24064
    s_mov_b64 exec, -1
    v_exp_f32 v37, v37
    v_exp_f32 v38, v38
    v_exp_f32 v39, v39
    v_cvt_pk_bf16_f32 v64, v32, v33
    v_cvt_pk_bf16_f32 v65, v34, v35
    v_cvt_pk_bf16_f32 v66, v36, v37
    v_cvt_pk_bf16_f32 v67, v38, v39
    v_exp_f32 v40, v40
    v_exp_f32 v41, v41
    v_mfma_f32_32x32x16_bf16 v[72:87], v[96:99], v[64:67], v[72:87]
    v_exp_f32 v42, v42
    v_exp_f32 v43, v43
    v_exp_f32 v44, v44
    s_cmp_ge_u32 s78, 1792
    s_cbranch_scc1 K2_NOCOPY
    s_waitcnt vmcnt(2)
    global_store_dwordx4 v119, v[132:135], s[14:15] sc1
K2_NOCOPY:
    v_exp_f32 v45, v45
    v_exp_f32 v46, v46
    v_exp_f32 v47, v47
    v_cvt_pk_bf16_f32 v68, v40, v41
    v_cvt_pk_bf16_f32 v69, v42, v43
    v_cvt_pk_bf16_f32 v70, v44, v45
    v_cvt_pk_bf16_f32 v71, v46, v47
    s_waitcnt lgkmcnt(0)
    v_mfma_f32_32x32x16_bf16 v[32:47], v[88:91], v[4:7], v[16:31]
    ds_read_b128 v[92:95], v112 offset:25600
    v_exp_f32 v48, v48
    v_exp_f32 v49, v49
    v_exp_f32 v50, v50
    v_exp_f32 v51, v51
    v_exp_f32 v52, v52
    v_mfma_f32_32x32x16_bf16 v[72:87], v[100:103], v[68:71], v[72:87]
    s_mov_b64 exec, s[42:43]
    ds_read_b128 v[96:99], v113 offset:24576
    ds_read_b128 v[100:103], v113 offset:25088
    s_mov_b64 exec, -1
    v_exp_f32 v53, v53
    v_exp_f32 v54, v54
    v_exp_f32 v55, v55
    v_cvt_pk_bf16_f32 v120, v48, v49
    v_cvt_pk_bf16_f32 v121, v50, v51
    v_cvt_pk_bf16_f32 v122, v52, v53
    v_cvt_pk_bf16_f32 v123, v54, v55
    v_exp_f32 v56, v56
    v_exp_f32 v57, v57
    v_mfma_f32_32x32x16_bf16 v[72:87], v[104:107], v[120:123], v[72:87]
    v_exp_f32 v58, v58
    v_exp_f32 v59, v59
    v_exp_f32 v60, v60
    v_exp_f32 v61, v61
    v_exp_f32 v62, v62
    v_exp_f32 v63, v63
    v_cvt_pk_bf16_f32 v124, v56, v57
    v_cvt_pk_bf16_f32 v125, v58, v59
    v_cvt_pk_bf16_f32 v126, v60, v61
    v_cvt_pk_bf16_f32 v127, v62, v63
    s_waitcnt lgkmcnt(0)
    v_mfma_f32_32x32x16_bf16 v[48:63], v[92:95], v[4:7], v[16:31]
    ds_read_b128 v[88:91], v112 offset:26624
    v_exp_f32 v32, v32
    v_exp_f32 v33, v33
    v_exp_f32 v34, v34
    v_exp_f32 v35, v35
    v_exp_f32 v36, v36
    v_mfma_f32_32x32x16_bf16 v[72:87], v[108:111], v[124:127], v[72:87]
    s_mov_b64 exec, s[42:43]
    ds_read_b128 v[104:107], v113 offset:25600
    ds_read_b128 v[108:111], v113 offset:26112
    s_mov_b64 exec, -1
    v_exp_f32 v37, v37
    v_exp_f32 v38, v38
    v_exp_f32 v39, v39
    v_cvt_pk_bf16_f32 v64, v32, v33
    v_cvt_pk_bf16_f32 v65, v34, v35
    v_cvt_pk_bf16_f32 v66, v36, v37
    v_cvt_pk_bf16_f32 v67, v38, v39
    v_exp_f32 v40, v40
    v_exp_f32 v41, v41
    v_mfma_f32_32x32x16_bf16 v[72:87], v[96:99], v[64:67], v[72:87]
    v_exp_f32 v42, v42
    v_exp_f32 v43, v43
    v_exp_f32 v44, v44
    global_load_dwordx4 v[128:131], v114, s[14:15] offset:-4096
    v_exp_f32 v45, v45
    v_exp_f32 v46, v46
    v_exp_f32 v47, v47
    v_cvt_pk_bf16_f32 v68, v40, v41
    v_cvt_pk_bf16_f32 v69, v42, v43
    v_cvt_pk_bf16_f32 v70, v44, v45
    v_cvt_pk_bf16_f32 v71, v46, v47
    s_waitcnt lgkmcnt(0)
    v_mfma_f32_32x32x16_bf16 v[32:47], v[88:91], v[4:7], v[16:31]
    ds_read_b128 v[92:95], v112 offset:27648
    v_exp_f32 v48, v48
    v_exp_f32 v49, v49
    v_exp_f32 v50, v50
    v_exp_f32 v51, v51
    v_exp_f32 v52, v52
    v_mfma_f32_32x32x16_bf16 v[72:87], v[100:103], v[68:71], v[72:87]
    s_mov_b64 exec, s[42:43]
    ds_read_b128 v[96:99], v113 offset:26624
    ds_read_b128 v[100:103], v113 offset:27136
    s_mov_b64 exec, -1
    v_exp_f32 v53, v53
    v_exp_f32 v54, v54
    v_exp_f32 v55, v55
    v_cvt_pk_bf16_f32 v120, v48, v49
    v_cvt_pk_bf16_f32 v121, v50, v51
    v_cvt_pk_bf16_f32 v122, v52, v53
    v_cvt_pk_bf16_f32 v123, v54, v55
    v_exp_f32 v56, v56
    v_exp_f32 v57, v57
    v_mfma_f32_32x32x16_bf16 v[72:87], v[104:107], v[120:123], v[72:87]
    v_exp_f32 v58, v58
    v_exp_f32 v59, v59
    v_exp_f32 v60, v60
    global_load_dwordx4 v[132:135], v115, s[14:15] offset:-4096
    v_exp_f32 v61, v61
    v_exp_f32 v62, v62
    v_exp_f32 v63, v63
    v_cvt_pk_bf16_f32 v124, v56, v57
    v_cvt_pk_bf16_f32 v125, v58, v59
    v_cvt_pk_bf16_f32 v126, v60, v61
    v_cvt_pk_bf16_f32 v127, v62, v63
    s_waitcnt lgkmcnt(0)
    v_mfma_f32_32x32x16_bf16 v[48:63], v[92:95], v[4:7], v[16:31]
    ds_read_b128 v[88:91], v112 offset:28672
    v_exp_f32 v32, v32
    v_exp_f32 v33, v33
    v_exp_f32 v34, v34
    v_exp_f32 v35, v35
    v_exp_f32 v36, v36
    v_mfma_f32_32x32x16_bf16 v[72:87], v[108:111], v[124:127], v[72:87]
    s_mov_b64 exec, s[42:43]
    ds_read_b128 v[104:107], v113 offset:27648
    ds_read_b128 v[108:111], v113 offset:28160
    s_mov_b64 exec, -1
    v_exp_f32 v37, v37
    v_exp_f32 v38, v38
    v_exp_f32 v39, v39
    v_cvt_pk_bf16_f32 v64, v32, v33
    v_cvt_pk_bf16_f32 v65, v34, v35
    v_cvt_pk_bf16_f32 v66, v36, v37
    v_cvt_pk_bf16_f32 v67, v38, v39
    v_exp_f32 v40, v40
    v_exp_f32 v41, v41
    v_mfma_f32_32x32x16_bf16 v[72:87], v[96:99], v[64:67], v[72:87]
    v_exp_f32 v42, v42
    v_exp_f32 v43, v43
    v_exp_f32 v44, v44
    global_load_dwordx4 v[136:139], v116, s[14:15] offset:-4096
    v_exp_f32 v45, v45
    v_exp_f32 v46, v46
    v_exp_f32 v47, v47
    v_cvt_pk_bf16_f32 v68, v40, v41
    v_cvt_pk_bf16_f32 v69, v42, v43
    v_cvt_pk_bf16_f32 v70, v44, v45
    v_cvt_pk_bf16_f32 v71, v46, v47
    s_waitcnt lgkmcnt(0)
    v_mfma_f32_32x32x16_bf16 v[32:47], v[88:91], v[4:7], v[16:31]
    ds_read_b128 v[92:95], v112 offset:29696
    v_exp_f32 v48, v48
    v_exp_f32 v49, v49
    v_exp_f32 v50, v50
    v_exp_f32 v51, v51
    v_exp_f32 v52, v52
    v_mfma_f32_32x32x16_bf16 v[72:87], v[100:103], v[68:71], v[72:87]
    s_mov_b64 exec, s[42:43]
    ds_read_b128 v[96:99], v113 offset:28672
    ds_read_b128 v[100:103], v113 offset:29184
    s_mov_b64 exec, -1
    v_exp_f32 v53, v53
    v_exp_f32 v54, v54
    v_exp_f32 v55, v55
    v_cvt_pk_bf16_f32 v120, v48, v49
    v_cvt_pk_bf16_f32 v121, v50, v51
    v_cvt_pk_bf16_f32 v122, v52, v53
    v_cvt_pk_bf16_f32 v123, v54, v55
    v_exp_f32 v56, v56
    v_exp_f32 v57, v57
    v_mfma_f32_32x32x16_bf16 v[72:87], v[104:107], v[120:123], v[72:87]
    v_exp_f32 v58, v58
    v_exp_f32 v59, v59
    v_exp_f32 v60, v60
    global_load_dwordx4 v[140:143], v117, s[14:15] offset:-4096
    v_exp_f32 v61, v61
    v_exp_f32 v62, v62
    v_exp_f32 v63, v63
    v_cvt_pk_bf16_f32 v124, v56, v57
    v_cvt_pk_bf16_f32 v125, v58, v59
    v_cvt_pk_bf16_f32 v126, v60, v61
    v_cvt_pk_bf16_f32 v127, v62, v63
    s_waitcnt lgkmcnt(0)
    v_mfma_f32_32x32x16_bf16 v[48:63], v[92:95], v[4:7], v[16:31]
    ds_read_b128 v[88:91], v112 offset:30720
    v_exp_f32 v32, v32
    v_exp_f32 v33, v33
    v_exp_f32 v34, v34
    v_exp_f32 v35, v35
    v_exp_f32 v36, v36
    v_mfma_f32_32x32x16_bf16 v[72:87], v[108:111], v[124:127], v[72:87]
    s_mov_b64 exec, s[42:43]
    ds_read_b128 v[104:107], v113 offset:29696
    ds_read_b128 v[108:111], v113 offset:30208
    s_mov_b64 exec, -1
    v_exp_f32 v37, v37
    v_exp_f32 v38, v38
    v_exp_f32 v39, v39
    v_cvt_pk_bf16_f32 v64, v32, v33
    v_cvt_pk_bf16_f32 v65, v34, v35
    v_cvt_pk_bf16_f32 v66, v36, v37
    v_cvt_pk_bf16_f32 v67, v38, v39
    v_exp_f32 v40, v40
    v_exp_f32 v41, v41
    v_mfma_f32_32x32x16_bf16 v[72:87], v[96:99], v[64:67], v[72:87]
    v_exp_f32 v42, v42
    v_exp_f32 v43, v43
    v_exp_f32 v44, v44
    global_load_dwordx4 v[144:147], v114, s[14:15] offset:-3072
    v_exp_f32 v45, v45
    v_exp_f32 v46, v46
    v_exp_f32 v47, v47
    v_cvt_pk_bf16_f32 v68, v40, v41
    v_cvt_pk_bf16_f32 v69, v42, v43
    v_cvt_pk_bf16_f32 v70, v44, v45
    v_cvt_pk_bf16_f32 v71, v46, v47
    s_waitcnt lgkmcnt(0)
    v_mfma_f32_32x32x16_bf16 v[32:47], v[88:91], v[4:7], v[16:31]
    ds_read_b128 v[92:95], v112 offset:31744
    v_exp_f32 v48, v48
    v_exp_f32 v49, v49
    v_exp_f32 v50, v50
    v_exp_f32 v51, v51
    v_exp_f32 v52, v52
    v_mfma_f32_32x32x16_bf16 v[72:87], v[100:103], v[68:71], v[72:87]
    s_mov_b64 exec, s[42:43]
    ds_read_b128 v[96:99], v113 offset:30720
    ds_read_b128 v[100:103], v113 offset:31232
    s_mov_b64 exec, -1
    v_exp_f32 v53, v53
    v_exp_f32 v54, v54
    v_exp_f32 v55, v55
    v_cvt_pk_bf16_f32 v120, v48, v49
    v_cvt_pk_bf16_f32 v121, v50, v51
    v_cvt_pk_bf16_f32 v122, v52, v53
    v_cvt_pk_bf16_f32 v123, v54, v55
    v_exp_f32 v56, v56
    v_exp_f32 v57, v57
    v_mfma_f32_32x32x16_bf16 v[72:87], v[104:107], v[120:123], v[72:87]
    v_exp_f32 v58, v58
    v_exp_f32 v59, v59
    v_exp_f32 v60, v60
    global_load_dwordx4 v[148:151], v115, s[14:15] offset:-3072
    v_exp_f32 v61, v61
    v_exp_f32 v62, v62
    v_exp_f32 v63, v63
    v_cvt_pk_bf16_f32 v124, v56, v57
    v_cvt_pk_bf16_f32 v125, v58, v59
    v_cvt_pk_bf16_f32 v126, v60, v61
    v_cvt_pk_bf16_f32 v127, v62, v63
    s_waitcnt lgkmcnt(0)
    v_mfma_f32_32x32x16_bf16 v[48:63], v[92:95], v[4:7], v[16:31]
    ds_read_b128 v[88:91], v112 offset:32768
    v_exp_f32 v32, v32
    v_exp_f32 v33, v33
    v_exp_f32 v34, v34
    v_exp_f32 v35, v35
    v_exp_f32 v36, v36
    v_mfma_f32_32x32x16_bf16 v[72:87], v[108:111], v[124:127], v[72:87]
    s_mov_b64 exec, s[42:43]
    ds_read_b128 v[104:107], v113 offset:31744
    ds_read_b128 v[108:111], v113 offset:32256
    s_mov_b64 exec, -1
    v_exp_f32 v37, v37
    v_exp_f32 v38, v38
    v_exp_f32 v39, v39
    v_cvt_pk_bf16_f32 v64, v32, v33
    v_cvt_pk_bf16_f32 v65, v34, v35
    v_cvt_pk_bf16_f32 v66, v36, v37
    v_cvt_pk_bf16_f32 v67, v38, v39
    v_exp_f32 v40, v40
    v_exp_f32 v41, v41
    v_mfma_f32_32x32x16_bf16 v[72:87], v[96:99], v[64:67], v[72:87]
    v_exp_f32 v42, v42
    v_exp_f32 v43, v43
    v_exp_f32 v44, v44
    global_load_dwordx4 v[152:155], v116, s[14:15] offset:-3072
    v_exp_f32 v45, v45
    v_exp_f32 v46, v46
    v_exp_f32 v47, v47
    v_cvt_pk_bf16_f32 v68, v40, v41
    v_cvt_pk_bf16_f32 v69, v42, v43
    v_cvt_pk_bf16_f32 v70, v44, v45
    v_cvt_pk_bf16_f32 v71, v46, v47
    s_waitcnt lgkmcnt(0)
    v_mfma_f32_32x32x16_bf16 v[32:47], v[88:91], v[4:7], v[16:31]
    ds_read_b128 v[92:95], v112 offset:33792
    v_exp_f32 v48, v48
    v_exp_f32 v49, v49
    v_exp_f32 v50, v50
    v_exp_f32 v51, v51
    v_exp_f32 v52, v52
    v_mfma_f32_32x32x16_bf16 v[72:87], v[100:103], v[68:71], v[72:87]
    s_mov_b64 exec, s[42:43]
    ds_read_b128 v[96:99], v113 offset:32768
    ds_read_b128 v[100:103], v113 offset:33280
    s_mov_b64 exec, -1
    v_exp_f32 v53, v53
    v_exp_f32 v54, v54
    v_exp_f32 v55, v55
    v_cvt_pk_bf16_f32 v120, v48, v49
    v_cvt_pk_bf16_f32 v121, v50, v51
    v_cvt_pk_bf16_f32 v122, v52, v53
    v_cvt_pk_bf16_f32 v123, v54, v55
    v_exp_f32 v56, v56
    v_exp_f32 v57, v57
    v_mfma_f32_32x32x16_bf16 v[72:87], v[104:107], v[120:123], v[72:87]
    v_exp_f32 v58, v58
    v_exp_f32 v59, v59
    v_exp_f32 v60, v60
    global_load_dwordx4 v[156:159], v117, s[14:15] offset:-3072
    v_exp_f32 v61, v61
    v_exp_f32 v62, v62
    v_exp_f32 v63, v63
    v_cvt_pk_bf16_f32 v124, v56, v57
    v_cvt_pk_bf16_f32 v125, v58, v59
    v_cvt_pk_bf16_f32 v126, v60, v61
    v_cvt_pk_bf16_f32 v127, v62, v63
    s_waitcnt lgkmcnt(0)
    v_mfma_f32_32x32x16_bf16 v[48:63], v[92:95], v[4:7], v[16:31]
    ds_read_b128 v[88:91], v112 offset:34816
    v_exp_f32 v32, v32
    v_exp_f32 v33, v33
    v_exp_f32 v34, v34
    v_exp_f32 v35, v35
    v_exp_f32 v36, v36
    v_mfma_f32_32x32x16_bf16 v[72:87], v[108:111], v[124:127], v[72:87]
    s_mov_b64 exec, s[42:43]
    ds_read_b128 v[104:107], v113 offset:33792
    ds_read_b128 v[108:111], v113 offset:34304
    s_mov_b64 exec, -1
    v_exp_f32 v37, v37
    v_exp_f32 v38, v38
    v_exp_f32 v39, v39
    v_cvt_pk_bf16_f32 v64, v32, v33
    v_cvt_pk_bf16_f32 v65, v34, v35
    v_cvt_pk_bf16_f32 v66, v36, v37
    v_cvt_pk_bf16_f32 v67, v38, v39
    v_exp_f32 v40, v40
    v_exp_f32 v41, v41
    v_mfma_f32_32x32x16_bf16 v[72:87], v[96:99], v[64:67], v[72:87]
    v_exp_f32 v42, v42
    v_exp_f32 v43, v43
    v_exp_f32 v44, v44
    global_load_dwordx4 v[160:163], v114, s[14:15] offset:-2048
    v_exp_f32 v45, v45
    v_exp_f32 v46, v46
    v_exp_f32 v47, v47
    v_cvt_pk_bf16_f32 v68, v40, v41
    v_cvt_pk_bf16_f32 v69, v42, v43
    v_cvt_pk_bf16_f32 v70, v44, v45
    v_cvt_pk_bf16_f32 v71, v46, v47
    s_waitcnt lgkmcnt(0)
    v_mfma_f32_32x32x16_bf16 v[32:47], v[88:91], v[4:7], v[16:31]
    ds_read_b128 v[92:95], v112 offset:35840
    v_exp_f32 v48, v48
    v_exp_f32 v49, v49
    v_exp_f32 v50, v50
    v_exp_f32 v51, v51
    v_exp_f32 v52, v52
    v_mfma_f32_32x32x16_bf16 v[72:87], v[100:103], v[68:71], v[72:87]
    s_mov_b64 exec, s[42:43]
    ds_read_b128 v[96:99], v113 offset:34816
    ds_read_b128 v[100:103], v113 offset:35328
    s_mov_b64 exec, -1
    v_exp_f32 v53, v53
    v_exp_f32 v54, v54
    v_exp_f32 v55, v55
    v_cvt_pk_bf16_f32 v120, v48, v49
    v_cvt_pk_bf16_f32 v121, v50, v51
    v_cvt_pk_bf16_f32 v122, v52, v53
    v_cvt_pk_bf16_f32 v123, v54, v55
    v_exp_f32 v56, v56
    v_exp_f32 v57, v57
    v_mfma_f32_32x32x16_bf16 v[72:87], v[104:107], v[120:123], v[72:87]
    v_exp_f32 v58, v58
    v_exp_f32 v59, v59
    v_exp_f32 v60, v60
    global_load_dwordx4 v[164:167], v115, s[14:15] offset:-2048
    v_exp_f32 v61, v61
    v_exp_f32 v62, v62
    v_exp_f32 v63, v63
    v_cvt_pk_bf16_f32 v124, v56, v57
    v_cvt_pk_bf16_f32 v125, v58, v59
    v_cvt_pk_bf16_f32 v126, v60, v61
    v_cvt_pk_bf16_f32 v127, v62, v63
    s_waitcnt lgkmcnt(0)
    v_mfma_f32_32x32x16_bf16 v[48:63], v[92:95], v[4:7], v[16:31]
    ds_read_b128 v[88:91], v112 offset:36864
    v_exp_f32 v32, v32
    v_exp_f32 v33, v33
    v_exp_f32 v34, v34
    v_exp_f32 v35, v35
    v_exp_f32 v36, v36
    v_mfma_f32_32x32x16_bf16 v[72:87], v[108:111], v[124:127], v[72:87]
    s_mov_b64 exec, s[42:43]
    ds_read_b128 v[104:107], v113 offset:35840
    ds_read_b128 v[108:111], v113 offset:36352
    s_mov_b64 exec, -1
    v_exp_f32 v37, v37
    v_exp_f32 v38, v38
    v_exp_f32 v39, v39
    v_cvt_pk_bf16_f32 v64, v32, v33
    v_cvt_pk_bf16_f32 v65, v34, v35
    v_cvt_pk_bf16_f32 v66, v36, v37
    v_cvt_pk_bf16_f32 v67, v38, v39
    v_exp_f32 v40, v40
    v_exp_f32 v41, v41
    v_mfma_f32_32x32x16_bf16 v[72:87], v[96:99], v[64:67], v[72:87]
    v_exp_f32 v42, v42
    v_exp_f32 v43, v43
    v_exp_f32 v44, v44
    global_load_dwordx4 v[168:171], v116, s[14:15] offset:-2048
    v_exp_f32 v45, v45
    v_exp_f32 v46, v46
    v_exp_f32 v47, v47
    v_cvt_pk_bf16_f32 v68, v40, v41
    v_cvt_pk_bf16_f32 v69, v42, v43
    v_cvt_pk_bf16_f32 v70, v44, v45
    v_cvt_pk_bf16_f32 v71, v46, v47
    s_waitcnt lgkmcnt(0)
    v_mfma_f32_32x32x16_bf16 v[32:47], v[88:91], v[4:7], v[16:31]
    ds_read_b128 v[92:95], v112 offset:37888
    v_exp_f32 v48, v48
    v_exp_f32 v49, v49
    v_exp_f32 v50, v50
    v_exp_f32 v51, v51
    v_exp_f32 v52, v52
    v_mfma_f32_32x32x16_bf16 v[72:87], v[100:103], v[68:71], v[72:87]
    s_mov_b64 exec, s[42:43]
    ds_read_b128 v[96:99], v113 offset:36864
    ds_read_b128 v[100:103], v113 offset:37376
    s_mov_b64 exec, -1
    v_exp_f32 v53, v53
    v_exp_f32 v54, v54
    v_exp_f32 v55, v55
    v_cvt_pk_bf16_f32 v120, v48, v49
    v_cvt_pk_bf16_f32 v121, v50, v51
    v_cvt_pk_bf16_f32 v122, v52, v53
    v_cvt_pk_bf16_f32 v123, v54, v55
    v_exp_f32 v56, v56
    v_exp_f32 v57, v57
    v_mfma_f32_32x32x16_bf16 v[72:87], v[104:107], v[120:123], v[72:87]
    v_exp_f32 v58, v58
    v_exp_f32 v59, v59
    v_exp_f32 v60, v60
    global_load_dwordx4 v[172:175], v117, s[14:15] offset:-2048
    v_exp_f32 v61, v61
    v_exp_f32 v62, v62
    v_exp_f32 v63, v63
    v_cvt_pk_bf16_f32 v124, v56, v57
    v_cvt_pk_bf16_f32 v125, v58, v59
    v_cvt_pk_bf16_f32 v126, v60, v61
    v_cvt_pk_bf16_f32 v127, v62, v63
    s_waitcnt lgkmcnt(0)
    v_mfma_f32_32x32x16_bf16 v[48:63], v[92:95], v[4:7], v[16:31]
    ds_read_b128 v[88:91], v112 offset:38912
    v_exp_f32 v32, v32
    v_exp_f32 v33, v33
    v_exp_f32 v34, v34
    v_exp_f32 v35, v35
    v_exp_f32 v36, v36
    v_mfma_f32_32x32x16_bf16 v[72:87], v[108:111], v[124:127], v[72:87]
    s_mov_b64 exec, s[42:43]
    ds_read_b128 v[104:107], v113 offset:37888
    ds_read_b128 v[108:111], v113 offset:38400
    s_mov_b64 exec, -1
    v_exp_f32 v37, v37
    v_exp_f32 v38, v38
    v_exp_f32 v39, v39
    v_cvt_pk_bf16_f32 v64, v32, v33
    v_cvt_pk_bf16_f32 v65, v34, v35
    v_cvt_pk_bf16_f32 v66, v36, v37
    v_cvt_pk_bf16_f32 v67, v38, v39
    v_exp_f32 v40, v40
    v_exp_f32 v41, v41
    v_mfma_f32_32x32x16_bf16 v[72:87], v[96:99], v[64:67], v[72:87]
    v_exp_f32 v42, v42
    v_exp_f32 v43, v43
    v_exp_f32 v44, v44
    global_load_dwordx4 v[176:179], v114, s[14:15] offset:-1024
    v_exp_f32 v45, v45
    v_exp_f32 v46, v46
    v_exp_f32 v47, v47
    v_cvt_pk_bf16_f32 v68, v40, v41
    v_cvt_pk_bf16_f32 v69, v42, v43
    v_cvt_pk_bf16_f32 v70, v44, v45
    v_cvt_pk_bf16_f32 v71, v46, v47
    s_waitcnt lgkmcnt(0)
    v_mfma_f32_32x32x16_bf16 v[32:47], v[88:91], v[4:7], v[16:31]
    ds_read_b128 v[92:95], v112 offset:39936
    v_exp_f32 v48, v48
    v_exp_f32 v49, v49
    v_exp_f32 v50, v50
    v_exp_f32 v51, v51
    v_exp_f32 v52, v52
    v_mfma_f32_32x32x16_bf16 v[72:87], v[100:103], v[68:71], v[72:87]
    s_mov_b64 exec, s[42:43]
    ds_read_b128 v[96:99], v113 offset:38912
    ds_read_b128 v[100:103], v113 offset:39424
    s_mov_b64 exec, -1
    v_exp_f32 v53, v53
    v_exp_f32 v54, v54
    v_exp_f32 v55, v55
    v_cvt_pk_bf16_f32 v120, v48, v49
    v_cvt_pk_bf16_f32 v121, v50, v51
    v_cvt_pk_bf16_f32 v122, v52, v53
    v_cvt_pk_bf16_f32 v123, v54, v55
    v_exp_f32 v56, v56
    v_exp_f32 v57, v57
    v_mfma_f32_32x32x16_bf16 v[72:87], v[104:107], v[120:123], v[72:87]
    v_exp_f32 v58, v58
    v_exp_f32 v59, v59
    v_exp_f32 v60, v60
    global_load_dwordx4 v[180:183], v115, s[14:15] offset:-1024
    v_exp_f32 v61, v61
    v_exp_f32 v62, v62
    v_exp_f32 v63, v63
    v_cvt_pk_bf16_f32 v124, v56, v57
    v_cvt_pk_bf16_f32 v125, v58, v59
    v_cvt_pk_bf16_f32 v126, v60, v61
    v_cvt_pk_bf16_f32 v127, v62, v63
    s_waitcnt lgkmcnt(0)
    v_mfma_f32_32x32x16_bf16 v[48:63], v[92:95], v[4:7], v[16:31]
    ds_read_b128 v[88:91], v112 offset:40960
    v_exp_f32 v32, v32
    v_exp_f32 v33, v33
    v_exp_f32 v34, v34
    v_exp_f32 v35, v35
    v_exp_f32 v36, v36
    v_mfma_f32_32x32x16_bf16 v[72:87], v[108:111], v[124:127], v[72:87]
    s_mov_b64 exec, s[42:43]
    ds_read_b128 v[104:107], v113 offset:39936
    ds_read_b128 v[108:111], v113 offset:40448
    s_mov_b64 exec, -1
    v_exp_f32 v37, v37
    v_exp_f32 v38, v38
    v_exp_f32 v39, v39
    v_cvt_pk_bf16_f32 v64, v32, v33
    v_cvt_pk_bf16_f32 v65, v34, v35
    v_cvt_pk_bf16_f32 v66, v36, v37
    v_cvt_pk_bf16_f32 v67, v38, v39
    v_exp_f32 v40, v40
    v_exp_f32 v41, v41
    v_mfma_f32_32x32x16_bf16 v[72:87], v[96:99], v[64:67], v[72:87]
    v_exp_f32 v42, v42
    v_exp_f32 v43, v43
    v_exp_f32 v44, v44
    global_load_dwordx4 v[184:187], v116, s[14:15] offset:-1024
    v_exp_f32 v45, v45
    v_exp_f32 v46, v46
    v_exp_f32 v47, v47
    v_cvt_pk_bf16_f32 v68, v40, v41
    v_cvt_pk_bf16_f32 v69, v42, v43
    v_cvt_pk_bf16_f32 v70, v44, v45
    v_cvt_pk_bf16_f32 v71, v46, v47
    s_waitcnt lgkmcnt(0)
    v_mfma_f32_32x32x16_bf16 v[32:47], v[88:91], v[4:7], v[16:31]
    ds_read_b128 v[92:95], v112 offset:41984
    v_exp_f32 v48, v48
    v_exp_f32 v49, v49
    v_exp_f32 v50, v50
    v_exp_f32 v51, v51
    v_exp_f32 v52, v52
    v_mfma_f32_32x32x16_bf16 v[72:87], v[100:103], v[68:71], v[72:87]
    s_mov_b64 exec, s[42:43]
    ds_read_b128 v[96:99], v113 offset:40960
    ds_read_b128 v[100:103], v113 offset:41472
    s_mov_b64 exec, -1
    v_exp_f32 v53, v53
    v_exp_f32 v54, v54
    v_exp_f32 v55, v55
    v_cvt_pk_bf16_f32 v120, v48, v49
    v_cvt_pk_bf16_f32 v121, v50, v51
    v_cvt_pk_bf16_f32 v122, v52, v53
    v_cvt_pk_bf16_f32 v123, v54, v55
    v_exp_f32 v56, v56
    v_exp_f32 v57, v57
    v_mfma_f32_32x32x16_bf16 v[72:87], v[104:107], v[120:123], v[72:87]
    v_exp_f32 v58, v58
    v_exp_f32 v59, v59
    v_exp_f32 v60, v60
    global_load_dwordx4 v[188:191], v117, s[14:15] offset:-1024
    v_exp_f32 v61, v61
    v_exp_f32 v62, v62
    v_exp_f32 v63, v63
    v_cvt_pk_bf16_f32 v124, v56, v57
    v_cvt_pk_bf16_f32 v125, v58, v59
    v_cvt_pk_bf16_f32 v126, v60, v61
    v_cvt_pk_bf16_f32 v127, v62, v63
    s_waitcnt lgkmcnt(0)
    v_mfma_f32_32x32x16_bf16 v[48:63], v[92:95], v[4:7], v[16:31]
    ds_read_b128 v[88:91], v112 offset:43008
    v_exp_f32 v32, v32
    v_exp_f32 v33, v33
    v_exp_f32 v34, v34
    v_exp_f32 v35, v35
    v_exp_f32 v36, v36
    v_mfma_f32_32x32x16_bf16 v[72:87], v[108:111], v[124:127], v[72:87]
    s_mov_b64 exec, s[42:43]
    ds_read_b128 v[104:107], v113 offset:41984
    ds_read_b128 v[108:111], v113 offset:42496
    s_mov_b64 exec, -1
    v_exp_f32 v37, v37
    v_exp_f32 v38, v38
    v_exp_f32 v39, v39
    v_cvt_pk_bf16_f32 v64, v32, v33
    v_cvt_pk_bf16_f32 v65, v34, v35
    v_cvt_pk_bf16_f32 v66, v36, v37
    v_cvt_pk_bf16_f32 v67, v38, v39
    v_exp_f32 v40, v40
    v_exp_f32 v41, v41
    v_mfma_f32_32x32x16_bf16 v[72:87], v[96:99], v[64:67], v[72:87]
    v_exp_f32 v42, v42
    v_exp_f32 v43, v43
    v_exp_f32 v44, v44
    global_load_dwordx4 v[192:195], v114, s[14:15] offset:0
    v_exp_f32 v45, v45
    v_exp_f32 v46, v46
    v_exp_f32 v47, v47
    v_cvt_pk_bf16_f32 v68, v40, v41
    v_cvt_pk_bf16_f32 v69, v42, v43
    v_cvt_pk_bf16_f32 v70, v44, v45
    v_cvt_pk_bf16_f32 v71, v46, v47
    s_waitcnt lgkmcnt(0)
    v_mfma_f32_32x32x16_bf16 v[32:47], v[88:91], v[4:7], v[16:31]
    ds_read_b128 v[92:95], v112 offset:44032
    v_exp_f32 v48, v48
    v_exp_f32 v49, v49
    v_exp_f32 v50, v50
    v_exp_f32 v51, v51
    v_exp_f32 v52, v52
    v_mfma_f32_32x32x16_bf16 v[72:87], v[100:103], v[68:71], v[72:87]
    s_mov_b64 exec, s[42:43]
    ds_read_b128 v[96:99], v113 offset:43008
    ds_read_b128 v[100:103], v113 offset:43520
    s_mov_b64 exec, -1
    v_exp_f32 v53, v53
    v_exp_f32 v54, v54
    v_exp_f32 v55, v55
    v_cvt_pk_bf16_f32 v120, v48, v49
    v_cvt_pk_bf16_f32 v121, v50, v51
    v_cvt_pk_bf16_f32 v122, v52, v53
    v_cvt_pk_bf16_f32 v123, v54, v55
    v_exp_f32 v56, v56
    v_exp_f32 v57, v57
    v_mfma_f32_32x32x16_bf16 v[72:87], v[104:107], v[120:123], v[72:87]
    v_exp_f32 v58, v58
    v_exp_f32 v59, v59
    v_exp_f32 v60, v60
    global_load_dwordx4 v[196:199], v115, s[14:15] offset:0
    v_exp_f32 v61, v61
    v_exp_f32 v62, v62
    v_exp_f32 v63, v63
    v_cvt_pk_bf16_f32 v124, v56, v57
    v_cvt_pk_bf16_f32 v125, v58, v59
    v_cvt_pk_bf16_f32 v126, v60, v61
    v_cvt_pk_bf16_f32 v127, v62, v63
    s_waitcnt lgkmcnt(0)
    v_mfma_f32_32x32x16_bf16 v[48:63], v[92:95], v[4:7], v[16:31]
    ds_read_b128 v[88:91], v112 offset:45056
    v_exp_f32 v32, v32
    v_exp_f32 v33, v33
    v_exp_f32 v34, v34
    v_exp_f32 v35, v35
    v_exp_f32 v36, v36
    v_mfma_f32_32x32x16_bf16 v[72:87], v[108:111], v[124:127], v[72:87]
    s_mov_b64 exec, s[42:43]
    ds_read_b128 v[104:107], v113 offset:44032
    ds_read_b128 v[108:111], v113 offset:44544
    s_mov_b64 exec, -1
    v_exp_f32 v37, v37
    v_exp_f32 v38, v38
    v_exp_f32 v39, v39
    v_cvt_pk_bf16_f32 v64, v32, v33
    v_cvt_pk_bf16_f32 v65, v34, v35
    v_cvt_pk_bf16_f32 v66, v36, v37
    v_cvt_pk_bf16_f32 v67, v38, v39
    v_exp_f32 v40, v40
    v_exp_f32 v41, v41
    v_mfma_f32_32x32x16_bf16 v[72:87], v[96:99], v[64:67], v[72:87]
    v_exp_f32 v42, v42
    v_exp_f32 v43, v43
    v_exp_f32 v44, v44
    global_load_dwordx4 v[200:203], v116, s[14:15] offset:0
    v_exp_f32 v45, v45
    v_exp_f32 v46, v46
    v_exp_f32 v47, v47
    v_cvt_pk_bf16_f32 v68, v40, v41
    v_cvt_pk_bf16_f32 v69, v42, v43
    v_cvt_pk_bf16_f32 v70, v44, v45
    v_cvt_pk_bf16_f32 v71, v46, v47
    s_waitcnt lgkmcnt(0)
    v_mfma_f32_32x32x16_bf16 v[32:47], v[88:91], v[4:7], v[16:31]
    ds_read_b128 v[92:95], v112 offset:46080
    v_exp_f32 v48, v48
    v_exp_f32 v49, v49
    v_exp_f32 v50, v50
    v_exp_f32 v51, v51
    v_exp_f32 v52, v52
    v_mfma_f32_32x32x16_bf16 v[72:87], v[100:103], v[68:71], v[72:87]
    s_mov_b64 exec, s[42:43]
    ds_read_b128 v[96:99], v113 offset:45056
    ds_read_b128 v[100:103], v113 offset:45568
    s_mov_b64 exec, -1
    v_exp_f32 v53, v53
    v_exp_f32 v54, v54
    v_exp_f32 v55, v55
    v_cvt_pk_bf16_f32 v120, v48, v49
    v_cvt_pk_bf16_f32 v121, v50, v51
    v_cvt_pk_bf16_f32 v122, v52, v53
    v_cvt_pk_bf16_f32 v123, v54, v55
    v_exp_f32 v56, v56
    v_exp_f32 v57, v57
    v_mfma_f32_32x32x16_bf16 v[72:87], v[104:107], v[120:123], v[72:87]
    v_exp_f32 v58, v58
    v_exp_f32 v59, v59
    v_exp_f32 v60, v60
    global_load_dwordx4 v[204:207], v117, s[14:15] offset:0
    v_exp_f32 v61, v61
    v_exp_f32 v62, v62
    v_exp_f32 v63, v63
    v_cvt_pk_bf16_f32 v124, v56, v57
    v_cvt_pk_bf16_f32 v125, v58, v59
    v_cvt_pk_bf16_f32 v126, v60, v61
    v_cvt_pk_bf16_f32 v127, v62, v63
    s_waitcnt lgkmcnt(0)
    v_mfma_f32_32x32x16_bf16 v[48:63], v[92:95], v[4:7], v[16:31]
    ds_read_b128 v[88:91], v112 offset:47104
    v_exp_f32 v32, v32
    v_exp_f32 v33, v33
    v_exp_f32 v34, v34
    v_exp_f32 v35, v35
    v_exp_f32 v36, v36
    v_mfma_f32_32x32x16_bf16 v[72:87], v[108:111], v[124:127], v[72:87]
    s_mov_b64 exec, s[42:43]
    ds_read_b128 v[104:107], v113 offset:46080
    ds_read_b128 v[108:111], v113 offset:46592
    s_mov_b64 exec, -1
    v_exp_f32 v37, v37
    v_exp_f32 v38, v38
    v_exp_f32 v39, v39
    v_cvt_pk_bf16_f32 v64, v32, v33
    v_cvt_pk_bf16_f32 v65, v34, v35
    v_cvt_pk_bf16_f32 v66, v36, v37
    v_cvt_pk_bf16_f32 v67, v38, v39
    v_exp_f32 v40, v40
    v_exp_f32 v41, v41
    v_mfma_f32_32x32x16_bf16 v[72:87], v[96:99], v[64:67], v[72:87]
    v_exp_f32 v42, v42
    v_exp_f32 v43, v43
    v_exp_f32 v44, v44
    global_load_dwordx4 v[208:211], v114, s[14:15] offset:1024
    v_exp_f32 v45, v45
    v_exp_f32 v46, v46
    v_exp_f32 v47, v47
    v_cvt_pk_bf16_f32 v68, v40, v41
    v_cvt_pk_bf16_f32 v69, v42, v43
    v_cvt_pk_bf16_f32 v70, v44, v45
    v_cvt_pk_bf16_f32 v71, v46, v47
    s_waitcnt lgkmcnt(0)
    v_mfma_f32_32x32x16_bf16 v[32:47], v[88:91], v[4:7], v[16:31]
    ds_read_b128 v[92:95], v112 offset:48128
    v_exp_f32 v48, v48
    v_exp_f32 v49, v49
    v_exp_f32 v50, v50
    v_exp_f32 v51, v51
    v_exp_f32 v52, v52
    v_mfma_f32_32x32x16_bf16 v[72:87], v[100:103], v[68:71], v[72:87]
    s_mov_b64 exec, s[42:43]
    ds_read_b128 v[96:99], v113 offset:47104
    ds_read_b128 v[100:103], v113 offset:47616
    s_mov_b64 exec, -1
    v_exp_f32 v53, v53
    v_exp_f32 v54, v54
    v_exp_f32 v55, v55
    v_cvt_pk_bf16_f32 v120, v48, v49
    v_cvt_pk_bf16_f32 v121, v50, v51
    v_cvt_pk_bf16_f32 v122, v52, v53
    v_cvt_pk_bf16_f32 v123, v54, v55
    v_exp_f32 v56, v56
    v_exp_f32 v57, v57
    v_mfma_f32_32x32x16_bf16 v[72:87], v[104:107], v[120:123], v[72:87]
    v_exp_f32 v58, v58
    v_exp_f32 v59, v59
    v_exp_f32 v60, v60
    global_load_dwordx4 v[212:215], v115, s[14:15] offset:1024
    v_exp_f32 v61, v61
    v_exp_f32 v62, v62
    v_exp_f32 v63, v63
    v_cvt_pk_bf16_f32 v124, v56, v57
    v_cvt_pk_bf16_f32 v125, v58, v59
    v_cvt_pk_bf16_f32 v126, v60, v61
    v_cvt_pk_bf16_f32 v127, v62, v63
    s_waitcnt lgkmcnt(0)
    v_mfma_f32_32x32x16_bf16 v[48:63], v[92:95], v[4:7], v[16:31]
    ds_read_b128 v[88:91], v112 offset:49152
    v_exp_f32 v32, v32
    v_exp_f32 v33, v33
    v_exp_f32 v34, v34
    v_exp_f32 v35, v35
    v_exp_f32 v36, v36
    v_mfma_f32_32x32x16_bf16 v[72:87], v[108:111], v[124:127], v[72:87]
    s_mov_b64 exec, s[42:43]
    ds_read_b128 v[104:107], v113 offset:48128
    ds_read_b128 v[108:111], v113 offset:48640
    s_mov_b64 exec, -1
    v_exp_f32 v37, v37
    v_exp_f32 v38, v38
    v_exp_f32 v39, v39
    v_cvt_pk_bf16_f32 v64, v32, v33
    v_cvt_pk_bf16_f32 v65, v34, v35
    v_cvt_pk_bf16_f32 v66, v36, v37
    v_cvt_pk_bf16_f32 v67, v38, v39
    v_exp_f32 v40, v40
    v_exp_f32 v41, v41
    v_mfma_f32_32x32x16_bf16 v[72:87], v[96:99], v[64:67], v[72:87]
    v_exp_f32 v42, v42
    v_exp_f32 v43, v43
    v_exp_f32 v44, v44
    global_load_dwordx4 v[216:219], v116, s[14:15] offset:1024
    v_exp_f32 v45, v45
    v_exp_f32 v46, v46
    v_exp_f32 v47, v47
    v_cvt_pk_bf16_f32 v68, v40, v41
    v_cvt_pk_bf16_f32 v69, v42, v43
    v_cvt_pk_bf16_f32 v70, v44, v45
    v_cvt_pk_bf16_f32 v71, v46, v47
    s_waitcnt lgkmcnt(0)
    v_mfma_f32_32x32x16_bf16 v[32:47], v[88:91], v[4:7], v[16:31]
    ds_read_b128 v[92:95], v112 offset:50176
    v_exp_f32 v48, v48
    v_exp_f32 v49, v49
    v_exp_f32 v50, v50
    v_exp_f32 v51, v51
    v_exp_f32 v52, v52
    v_mfma_f32_32x32x16_bf16 v[72:87], v[100:103], v[68:71], v[72:87]
    s_mov_b64 exec, s[42:43]
    ds_read_b128 v[96:99], v113 offset:49152
    ds_read_b128 v[100:103], v113 offset:49664
    s_mov_b64 exec, -1
    v_exp_f32 v53, v53
    v_exp_f32 v54, v54
    v_exp_f32 v55, v55
    v_cvt_pk_bf16_f32 v120, v48, v49
    v_cvt_pk_bf16_f32 v121, v50, v51
    v_cvt_pk_bf16_f32 v122, v52, v53
    v_cvt_pk_bf16_f32 v123, v54, v55
    v_exp_f32 v56, v56
    v_exp_f32 v57, v57
    v_mfma_f32_32x32x16_bf16 v[72:87], v[104:107], v[120:123], v[72:87]
    v_exp_f32 v58, v58
    v_exp_f32 v59, v59
    v_exp_f32 v60, v60
    global_load_dwordx4 v[220:223], v117, s[14:15] offset:1024
    v_exp_f32 v61, v61
    v_exp_f32 v62, v62
    v_exp_f32 v63, v63
    v_cvt_pk_bf16_f32 v124, v56, v57
    v_cvt_pk_bf16_f32 v125, v58, v59
    v_cvt_pk_bf16_f32 v126, v60, v61
    v_cvt_pk_bf16_f32 v127, v62, v63
    s_waitcnt lgkmcnt(0)
    v_mfma_f32_32x32x16_bf16 v[48:63], v[92:95], v[4:7], v[16:31]
    ds_read_b128 v[88:91], v112 offset:51200
    v_exp_f32 v32, v32
    v_exp_f32 v33, v33
    v_exp_f32 v34, v34
    v_exp_f32 v35, v35
    v_exp_f32 v36, v36
    v_mfma_f32_32x32x16_bf16 v[72:87], v[108:111], v[124:127], v[72:87]
    s_mov_b64 exec, s[42:43]
    ds_read_b128 v[104:107], v113 offset:50176
    ds_read_b128 v[108:111], v113 offset:50688
    s_mov_b64 exec, -1
    v_exp_f32 v37, v37
    v_exp_f32 v38, v38
    v_exp_f32 v39, v39
    v_cvt_pk_bf16_f32 v64, v32, v33
    v_cvt_pk_bf16_f32 v65, v34, v35
    v_cvt_pk_bf16_f32 v66, v36, v37
    v_cvt_pk_bf16_f32 v67, v38, v39
    v_exp_f32 v40, v40
    v_exp_f32 v41, v41
    v_mfma_f32_32x32x16_bf16 v[72:87], v[96:99], v[64:67], v[72:87]
    v_exp_f32 v42, v42
    v_exp_f32 v43, v43
    v_exp_f32 v44, v44
    global_load_dwordx4 v[224:227], v114, s[14:15] offset:2048
    v_exp_f32 v45, v45
    v_exp_f32 v46, v46
    v_exp_f32 v47, v47
    v_cvt_pk_bf16_f32 v68, v40, v41
    v_cvt_pk_bf16_f32 v69, v42, v43
    v_cvt_pk_bf16_f32 v70, v44, v45
    v_cvt_pk_bf16_f32 v71, v46, v47
    s_waitcnt lgkmcnt(0)
    v_mfma_f32_32x32x16_bf16 v[32:47], v[88:91], v[4:7], v[16:31]
    ds_read_b128 v[92:95], v112 offset:52224
    v_exp_f32 v48, v48
    v_exp_f32 v49, v49
    v_exp_f32 v50, v50
    v_exp_f32 v51, v51
    v_exp_f32 v52, v52
    v_mfma_f32_32x32x16_bf16 v[72:87], v[100:103], v[68:71], v[72:87]
    s_mov_b64 exec, s[42:43]
    ds_read_b128 v[96:99], v113 offset:51200
    ds_read_b128 v[100:103], v113 offset:51712
    s_mov_b64 exec, -1
    v_exp_f32 v53, v53
    v_exp_f32 v54, v54
    v_exp_f32 v55, v55
    v_cvt_pk_bf16_f32 v120, v48, v49
    v_cvt_pk_bf16_f32 v121, v50, v51
    v_cvt_pk_bf16_f32 v122, v52, v53
    v_cvt_pk_bf16_f32 v123, v54, v55
    v_exp_f32 v56, v56
    v_exp_f32 v57, v57
    v_mfma_f32_32x32x16_bf16 v[72:87], v[104:107], v[120:123], v[72:87]
    v_exp_f32 v58, v58
    v_exp_f32 v59, v59
    v_exp_f32 v60, v60
    global_load_dwordx4 v[228:231], v115, s[14:15] offset:2048
    v_exp_f32 v61, v61
    v_exp_f32 v62, v62
    v_exp_f32 v63, v63
    v_cvt_pk_bf16_f32 v124, v56, v57
    v_cvt_pk_bf16_f32 v125, v58, v59
    v_cvt_pk_bf16_f32 v126, v60, v61
    v_cvt_pk_bf16_f32 v127, v62, v63
    s_waitcnt lgkmcnt(0)
    v_mfma_f32_32x32x16_bf16 v[48:63], v[92:95], v[4:7], v[16:31]
    ds_read_b128 v[88:91], v112 offset:53248
    v_exp_f32 v32, v32
    v_exp_f32 v33, v33
    v_exp_f32 v34, v34
    v_exp_f32 v35, v35
    v_exp_f32 v36, v36
    v_mfma_f32_32x32x16_bf16 v[72:87], v[108:111], v[124:127], v[72:87]
    s_mov_b64 exec, s[42:43]
    ds_read_b128 v[104:107], v113 offset:52224
    ds_read_b128 v[108:111], v113 offset:52736
    s_mov_b64 exec, -1
    v_exp_f32 v37, v37
    v_exp_f32 v38, v38
    v_exp_f32 v39, v39
    v_cvt_pk_bf16_f32 v64, v32, v33
    v_cvt_pk_bf16_f32 v65, v34, v35
    v_cvt_pk_bf16_f32 v66, v36, v37
    v_cvt_pk_bf16_f32 v67, v38, v39
    v_exp_f32 v40, v40
    v_exp_f32 v41, v41
    v_mfma_f32_32x32x16_bf16 v[72:87], v[96:99], v[64:67], v[72:87]
    v_exp_f32 v42, v42
    v_exp_f32 v43, v43
    v_exp_f32 v44, v44
    global_load_dwordx4 v[232:235], v116, s[14:15] offset:2048
    v_exp_f32 v45, v45
    v_exp_f32 v46, v46
    v_exp_f32 v47, v47
    v_cvt_pk_bf16_f32 v68, v40, v41
    v_cvt_pk_bf16_f32 v69, v42, v43
    v_cvt_pk_bf16_f32 v70, v44, v45
    v_cvt_pk_bf16_f32 v71, v46, v47
    s_waitcnt lgkmcnt(0)
    v_mfma_f32_32x32x16_bf16 v[32:47], v[88:91], v[4:7], v[16:31]
    ds_read_b128 v[92:95], v112 offset:54272
    v_exp_f32 v48, v48
    v_exp_f32 v49, v49
    v_exp_f32 v50, v50
    v_exp_f32 v51, v51
    v_exp_f32 v52, v52
    v_mfma_f32_32x32x16_bf16 v[72:87], v[100:103], v[68:71], v[72:87]
    s_mov_b64 exec, s[42:43]
    ds_read_b128 v[96:99], v113 offset:53248
    ds_read_b128 v[100:103], v113 offset:53760
    s_mov_b64 exec, -1
    v_exp_f32 v53, v53
    v_exp_f32 v54, v54
    v_exp_f32 v55, v55
    v_cvt_pk_bf16_f32 v120, v48, v49
    v_cvt_pk_bf16_f32 v121, v50, v51
    v_cvt_pk_bf16_f32 v122, v52, v53
    v_cvt_pk_bf16_f32 v123, v54, v55
    v_exp_f32 v56, v56
    v_exp_f32 v57, v57
    v_mfma_f32_32x32x16_bf16 v[72:87], v[104:107], v[120:123], v[72:87]
    v_exp_f32 v58, v58
    v_exp_f32 v59, v59
    v_exp_f32 v60, v60
    global_load_dwordx4 v[236:239], v117, s[14:15] offset:2048
    v_exp_f32 v61, v61
    v_exp_f32 v62, v62
    v_exp_f32 v63, v63
    v_cvt_pk_bf16_f32 v124, v56, v57
    v_cvt_pk_bf16_f32 v125, v58, v59
    v_cvt_pk_bf16_f32 v126, v60, v61
    v_cvt_pk_bf16_f32 v127, v62, v63
    s_waitcnt lgkmcnt(0)
    v_mfma_f32_32x32x16_bf16 v[48:63], v[92:95], v[4:7], v[16:31]
    ds_read_b128 v[88:91], v112 offset:55296
    v_exp_f32 v32, v32
    v_exp_f32 v33, v33
    v_exp_f32 v34, v34
    v_exp_f32 v35, v35
    v_exp_f32 v36, v36
    v_mfma_f32_32x32x16_bf16 v[72:87], v[108:111], v[124:127], v[72:87]
    s_mov_b64 exec, s[42:43]
    ds_read_b128 v[104:107], v113 offset:54272
    ds_read_b128 v[108:111], v113 offset:54784
    s_mov_b64 exec, -1
    v_exp_f32 v37, v37
    v_exp_f32 v38, v38
    v_exp_f32 v39, v39
    v_cvt_pk_bf16_f32 v64, v32, v33
    v_cvt_pk_bf16_f32 v65, v34, v35
    v_cvt_pk_bf16_f32 v66, v36, v37
    v_cvt_pk_bf16_f32 v67, v38, v39
    v_exp_f32 v40, v40
    v_exp_f32 v41, v41
    v_mfma_f32_32x32x16_bf16 v[72:87], v[96:99], v[64:67], v[72:87]
    v_exp_f32 v42, v42
    v_exp_f32 v43, v43
    v_exp_f32 v44, v44
    global_load_dwordx4 v[240:243], v114, s[14:15] offset:3072
    v_exp_f32 v45, v45
    v_exp_f32 v46, v46
    v_exp_f32 v47, v47
    v_cvt_pk_bf16_f32 v68, v40, v41
    v_cvt_pk_bf16_f32 v69, v42, v43
    v_cvt_pk_bf16_f32 v70, v44, v45
    v_cvt_pk_bf16_f32 v71, v46, v47
    s_waitcnt lgkmcnt(0)
    v_mfma_f32_32x32x16_bf16 v[32:47], v[88:91], v[4:7], v[16:31]
    ds_read_b128 v[92:95], v112 offset:56320
    v_exp_f32 v48, v48
    v_exp_f32 v49, v49
    v_exp_f32 v50, v50
    v_exp_f32 v51, v51
    v_exp_f32 v52, v52
    v_mfma_f32_32x32x16_bf16 v[72:87], v[100:103], v[68:71], v[72:87]
    s_mov_b64 exec, s[42:43]
    ds_read_b128 v[96:99], v113 offset:55296
    ds_read_b128 v[100:103], v113 offset:55808
    s_mov_b64 exec, -1
    v_exp_f32 v53, v53
    v_exp_f32 v54, v54
    v_exp_f32 v55, v55
    v_cvt_pk_bf16_f32 v120, v48, v49
    v_cvt_pk_bf16_f32 v121, v50, v51
    v_cvt_pk_bf16_f32 v122, v52, v53
    v_cvt_pk_bf16_f32 v123, v54, v55
    v_exp_f32 v56, v56
    v_exp_f32 v57, v57
    v_mfma_f32_32x32x16_bf16 v[72:87], v[104:107], v[120:123], v[72:87]
    v_exp_f32 v58, v58
    v_exp_f32 v59, v59
    v_exp_f32 v60, v60
    global_load_dwordx4 v[244:247], v115, s[14:15] offset:3072
    v_exp_f32 v61, v61
    v_exp_f32 v62, v62
    v_exp_f32 v63, v63
    v_cvt_pk_bf16_f32 v124, v56, v57
    v_cvt_pk_bf16_f32 v125, v58, v59
    v_cvt_pk_bf16_f32 v126, v60, v61
    v_cvt_pk_bf16_f32 v127, v62, v63
    s_waitcnt lgkmcnt(0)
    v_mfma_f32_32x32x16_bf16 v[48:63], v[92:95], v[4:7], v[16:31]
    ds_read_b128 v[88:91], v112 offset:57344
    v_exp_f32 v32, v32
    v_exp_f32 v33, v33
    v_exp_f32 v34, v34
    v_exp_f32 v35, v35
    v_exp_f32 v36, v36
    v_mfma_f32_32x32x16_bf16 v[72:87], v[108:111], v[124:127], v[72:87]
    s_mov_b64 exec, s[42:43]
    ds_read_b128 v[104:107], v113 offset:56320
    ds_read_b128 v[108:111], v113 offset:56832
    s_mov_b64 exec, -1
    v_exp_f32 v37, v37
    v_exp_f32 v38, v38
    v_exp_f32 v39, v39
    v_cvt_pk_bf16_f32 v64, v32, v33
    v_cvt_pk_bf16_f32 v65, v34, v35
    v_cvt_pk_bf16_f32 v66, v36, v37
    v_cvt_pk_bf16_f32 v67, v38, v39
    v_exp_f32 v40, v40
    v_exp_f32 v41, v41
    v_mfma_f32_32x32x16_bf16 v[72:87], v[96:99], v[64:67], v[72:87]
    v_exp_f32 v42, v42
    v_exp_f32 v43, v43
    v_exp_f32 v44, v44
    global_load_dwordx4 v[248:251], v116, s[14:15] offset:3072
    v_exp_f32 v45, v45
    v_exp_f32 v46, v46
    v_exp_f32 v47, v47
    v_cvt_pk_bf16_f32 v68, v40, v41
    v_cvt_pk_bf16_f32 v69, v42, v43
    v_cvt_pk_bf16_f32 v70, v44, v45
    v_cvt_pk_bf16_f32 v71, v46, v47
    s_waitcnt lgkmcnt(0)
    v_mfma_f32_32x32x16_bf16 v[32:47], v[88:91], v[4:7], v[16:31]
    ds_read_b128 v[92:95], v112 offset:58368
    v_exp_f32 v48, v48
    v_exp_f32 v49, v49
    v_exp_f32 v50, v50
    v_exp_f32 v51, v51
    v_exp_f32 v52, v52
    v_mfma_f32_32x32x16_bf16 v[72:87], v[100:103], v[68:71], v[72:87]
    s_mov_b64 exec, s[42:43]
    ds_read_b128 v[96:99], v113 offset:57344
    ds_read_b128 v[100:103], v113 offset:57856
    s_mov_b64 exec, -1
    v_exp_f32 v53, v53
    v_exp_f32 v54, v54
    v_exp_f32 v55, v55
    v_cvt_pk_bf16_f32 v120, v48, v49
    v_cvt_pk_bf16_f32 v121, v50, v51
    v_cvt_pk_bf16_f32 v122, v52, v53
    v_cvt_pk_bf16_f32 v123, v54, v55
    v_exp_f32 v56, v56
    v_exp_f32 v57, v57
    v_mfma_f32_32x32x16_bf16 v[72:87], v[104:107], v[120:123], v[72:87]
    v_exp_f32 v58, v58
    v_exp_f32 v59, v59
    v_exp_f32 v60, v60
    global_load_dwordx4 v[252:255], v117, s[14:15] offset:3072
    v_exp_f32 v61, v61
    v_exp_f32 v62, v62
    v_exp_f32 v63, v63
    v_cvt_pk_bf16_f32 v124, v56, v57
    v_cvt_pk_bf16_f32 v125, v58, v59
    v_cvt_pk_bf16_f32 v126, v60, v61
    v_cvt_pk_bf16_f32 v127, v62, v63
    s_waitcnt lgkmcnt(0)
    v_mfma_f32_32x32x16_bf16 v[48:63], v[92:95], v[4:7], v[16:31]
    ds_read_b128 v[88:91], v112 offset:59392
    v_exp_f32 v32, v32
    v_exp_f32 v33, v33
    v_exp_f32 v34, v34
    v_exp_f32 v35, v35
    v_exp_f32 v36, v36
    v_mfma_f32_32x32x16_bf16 v[72:87], v[108:111], v[124:127], v[72:87]
    s_mov_b64 exec, s[42:43]
    ds_read_b128 v[104:107], v113 offset:58368
    ds_read_b128 v[108:111], v113 offset:58880
    s_mov_b64 exec, -1
    v_exp_f32 v37, v37
    v_exp_f32 v38, v38
    v_exp_f32 v39, v39
    v_cvt_pk_bf16_f32 v64, v32, v33
    v_cvt_pk_bf16_f32 v65, v34, v35
    v_cvt_pk_bf16_f32 v66, v36, v37
    v_cvt_pk_bf16_f32 v67, v38, v39
    v_exp_f32 v40, v40
    v_exp_f32 v41, v41
    v_mfma_f32_32x32x16_bf16 v[72:87], v[96:99], v[64:67], v[72:87]
    v_exp_f32 v42, v42
    v_exp_f32 v43, v43
    v_exp_f32 v44, v44
    v_exp_f32 v45, v45
    v_exp_f32 v46, v46
    v_exp_f32 v47, v47
    v_cvt_pk_bf16_f32 v68, v40, v41
    v_cvt_pk_bf16_f32 v69, v42, v43
    v_cvt_pk_bf16_f32 v70, v44, v45
    v_cvt_pk_bf16_f32 v71, v46, v47
    s_waitcnt lgkmcnt(0)
    v_mfma_f32_32x32x16_bf16 v[32:47], v[88:91], v[4:7], v[16:31]
    ds_read_b128 v[92:95], v112 offset:60416
    v_exp_f32 v48, v48
    v_exp_f32 v49, v49
    v_exp_f32 v50, v50
    v_exp_f32 v51, v51
    v_exp_f32 v52, v52
    v_mfma_f32_32x32x16_bf16 v[72:87], v[100:103], v[68:71], v[72:87]
    s_mov_b64 exec, s[42:43]
    ds_read_b128 v[96:99], v113 offset:59392
    ds_read_b128 v[100:103], v113 offset:59904
    s_mov_b64 exec, -1
    v_exp_f32 v53, v53
    v_exp_f32 v54, v54
    v_exp_f32 v55, v55
    v_cvt_pk_bf16_f32 v120, v48, v49
    v_cvt_pk_bf16_f32 v121, v50, v51
    v_cvt_pk_bf16_f32 v122, v52, v53
    v_cvt_pk_bf16_f32 v123, v54, v55
    v_exp_f32 v56, v56
    v_exp_f32 v57, v57
    v_mfma_f32_32x32x16_bf16 v[72:87], v[104:107], v[120:123], v[72:87]
    v_exp_f32 v58, v58
    v_exp_f32 v59, v59
    v_exp_f32 v60, v60
    v_exp_f32 v61, v61
    v_exp_f32 v62, v62
    v_exp_f32 v63, v63
    v_cvt_pk_bf16_f32 v124, v56, v57
    v_cvt_pk_bf16_f32 v125, v58, v59
    v_cvt_pk_bf16_f32 v126, v60, v61
    v_cvt_pk_bf16_f32 v127, v62, v63
    s_waitcnt lgkmcnt(0)
    v_mfma_f32_32x32x16_bf16 v[48:63], v[92:95], v[4:7], v[16:31]
    ds_read_b128 v[88:91], v112 offset:61440
    v_exp_f32 v32, v32
    v_exp_f32 v33, v33
    v_exp_f32 v34, v34
    v_exp_f32 v35, v35
    v_exp_f32 v36, v36
    v_mfma_f32_32x32x16_bf16 v[72:87], v[108:111], v[124:127], v[72:87]
    s_mov_b64 exec, s[42:43]
    ds_read_b128 v[104:107], v113 offset:60416
    ds_read_b128 v[108:111], v113 offset:60928
    s_mov_b64 exec, -1
    v_exp_f32 v37, v37
    v_exp_f32 v38, v38
    v_exp_f32 v39, v39
    v_cvt_pk_bf16_f32 v64, v32, v33
    v_cvt_pk_bf16_f32 v65, v34, v35
    v_cvt_pk_bf16_f32 v66, v36, v37
    v_cvt_pk_bf16_f32 v67, v38, v39
    v_exp_f32 v40, v40
    v_exp_f32 v41, v41
    v_mfma_f32_32x32x16_bf16 v[72:87], v[96:99], v[64:67], v[72:87]
    v_exp_f32 v42, v42
    v_exp_f32 v43, v43
    v_exp_f32 v44, v44
    v_exp_f32 v45, v45
    v_exp_f32 v46, v46
    v_exp_f32 v47, v47
    v_cvt_pk_bf16_f32 v68, v40, v41
    v_cvt_pk_bf16_f32 v69, v42, v43
    v_cvt_pk_bf16_f32 v70, v44, v45
    v_cvt_pk_bf16_f32 v71, v46, v47
    s_waitcnt lgkmcnt(0)
    v_mfma_f32_32x32x16_bf16 v[32:47], v[88:91], v[4:7], v[16:31]
    ds_read_b128 v[92:95], v112 offset:62464
    v_exp_f32 v48, v48
    v_exp_f32 v49, v49
    v_exp_f32 v50, v50
    v_exp_f32 v51, v51
    v_exp_f32 v52, v52
    v_mfma_f32_32x32x16_bf16 v[72:87], v[100:103], v[68:71], v[72:87]
    s_mov_b64 exec, s[42:43]
    ds_read_b128 v[96:99], v113 offset:61440
    ds_read_b128 v[100:103], v113 offset:61952
    s_mov_b64 exec, -1
    v_exp_f32 v53, v53
    v_exp_f32 v54, v54
    v_exp_f32 v55, v55
    v_cvt_pk_bf16_f32 v120, v48, v49
    v_cvt_pk_bf16_f32 v121, v50, v51
    v_cvt_pk_bf16_f32 v122, v52, v53
    v_cvt_pk_bf16_f32 v123, v54, v55
    v_exp_f32 v56, v56
    v_exp_f32 v57, v57
    v_mfma_f32_32x32x16_bf16 v[72:87], v[104:107], v[120:123], v[72:87]
    v_exp_f32 v58, v58
    v_exp_f32 v59, v59
    v_exp_f32 v60, v60
    v_exp_f32 v61, v61
    v_exp_f32 v62, v62
    v_exp_f32 v63, v63
    v_cvt_pk_bf16_f32 v124, v56, v57
    v_cvt_pk_bf16_f32 v125, v58, v59
    v_cvt_pk_bf16_f32 v126, v60, v61
    v_cvt_pk_bf16_f32 v127, v62, v63
    s_waitcnt lgkmcnt(0)
    v_mfma_f32_32x32x16_bf16 v[48:63], v[92:95], v[4:7], v[16:31]
    ds_read_b128 v[88:91], v112 offset:63488
    v_exp_f32 v32, v32
    v_exp_f32 v33, v33
    v_exp_f32 v34, v34
    v_exp_f32 v35, v35
    v_exp_f32 v36, v36
    v_mfma_f32_32x32x16_bf16 v[72:87], v[108:111], v[124:127], v[72:87]
    s_mov_b64 exec, s[42:43]
    ds_read_b128 v[104:107], v113 offset:62464
    ds_read_b128 v[108:111], v113 offset:62976
    s_mov_b64 exec, -1
    v_exp_f32 v37, v37
    v_exp_f32 v38, v38
    v_exp_f32 v39, v39
    v_cvt_pk_bf16_f32 v64, v32, v33
    v_cvt_pk_bf16_f32 v65, v34, v35
    v_cvt_pk_bf16_f32 v66, v36, v37
    v_cvt_pk_bf16_f32 v67, v38, v39
    v_exp_f32 v40, v40
    v_exp_f32 v41, v41
    v_mfma_f32_32x32x16_bf16 v[72:87], v[96:99], v[64:67], v[72:87]
    v_exp_f32 v42, v42
    v_exp_f32 v43, v43
    v_exp_f32 v44, v44
    v_exp_f32 v45, v45
    v_exp_f32 v46, v46
    v_exp_f32 v47, v47
    v_cvt_pk_bf16_f32 v68, v40, v41
    v_cvt_pk_bf16_f32 v69, v42, v43
    v_cvt_pk_bf16_f32 v70, v44, v45
    v_cvt_pk_bf16_f32 v71, v46, v47
    s_waitcnt lgkmcnt(0)
    v_mfma_f32_32x32x16_bf16 v[32:47], v[88:91], v[4:7], v[16:31]
    ds_read_b128 v[92:95], v112 offset:64512
    v_exp_f32 v48, v48
    v_exp_f32 v49, v49
    v_exp_f32 v50, v50
    v_exp_f32 v51, v51
    v_exp_f32 v52, v52
    v_mfma_f32_32x32x16_bf16 v[72:87], v[100:103], v[68:71], v[72:87]
    s_mov_b64 exec, s[42:43]
    ds_read_b128 v[96:99], v113 offset:63488
    ds_read_b128 v[100:103], v113 offset:64000
    s_mov_b64 exec, -1
    v_exp_f32 v53, v53
    v_exp_f32 v54, v54
    v_exp_f32 v55, v55
    v_cvt_pk_bf16_f32 v120, v48, v49
    v_cvt_pk_bf16_f32 v121, v50, v51
    v_cvt_pk_bf16_f32 v122, v52, v53
    v_cvt_pk_bf16_f32 v123, v54, v55
    v_exp_f32 v56, v56
    v_exp_f32 v57, v57
    v_mfma_f32_32x32x16_bf16 v[72:87], v[104:107], v[120:123], v[72:87]
    v_exp_f32 v58, v58
    v_exp_f32 v59, v59
    v_exp_f32 v60, v60
    v_exp_f32 v61, v61
    v_exp_f32 v62, v62
    v_exp_f32 v63, v63
    v_cvt_pk_bf16_f32 v124, v56, v57
    v_cvt_pk_bf16_f32 v125, v58, v59
    v_cvt_pk_bf16_f32 v126, v60, v61
    v_cvt_pk_bf16_f32 v127, v62, v63
    s_waitcnt lgkmcnt(0)
    v_mfma_f32_32x32x16_bf16 v[48:63], v[92:95], v[4:7], v[16:31]
    v_exp_f32 v32, v32
    v_exp_f32 v33, v33
    v_exp_f32 v34, v34
    v_exp_f32 v35, v35
    v_exp_f32 v36, v36
    v_mfma_f32_32x32x16_bf16 v[72:87], v[108:111], v[124:127], v[72:87]
    s_mov_b64 exec, s[42:43]
    ds_read_b128 v[104:107], v113 offset:64512
    ds_read_b128 v[108:111], v113 offset:65024
    s_mov_b64 exec, -1
    v_exp_f32 v37, v37
    v_exp_f32 v38, v38
    v_exp_f32 v39, v39
    v_cvt_pk_bf16_f32 v64, v32, v33
    v_cvt_pk_bf16_f32 v65, v34, v35
    v_cvt_pk_bf16_f32 v66, v36, v37
    v_cvt_pk_bf16_f32 v67, v38, v39
    v_exp_f32 v40, v40
    v_exp_f32 v41, v41
    v_mfma_f32_32x32x16_bf16 v[72:87], v[96:99], v[64:67], v[72:87]
    v_exp_f32 v42, v42
    v_exp_f32 v43, v43
    v_exp_f32 v44, v44
    v_exp_f32 v45, v45
    v_exp_f32 v46, v46
    v_exp_f32 v47, v47
    v_cvt_pk_bf16_f32 v68, v40, v41
    v_cvt_pk_bf16_f32 v69, v42, v43
    v_cvt_pk_bf16_f32 v70, v44, v45
    v_cvt_pk_bf16_f32 v71, v46, v47
    s_waitcnt lgkmcnt(0)
    v_exp_f32 v48, v48
    v_exp_f32 v49, v49
    v_exp_f32 v50, v50
    v_exp_f32 v51, v51
    v_exp_f32 v52, v52
    v_mfma_f32_32x32x16_bf16 v[72:87], v[100:103], v[68:71], v[72:87]
    v_exp_f32 v53, v53
    v_exp_f32 v54, v54
    v_exp_f32 v55, v55
    v_cvt_pk_bf16_f32 v120, v48, v49
    v_cvt_pk_bf16_f32 v121, v50, v51
    v_cvt_pk_bf16_f32 v122, v52, v53
    v_cvt_pk_bf16_f32 v123, v54, v55
    v_exp_f32 v56, v56
    v_exp_f32 v57, v57
    v_mfma_f32_32x32x16_bf16 v[72:87], v[104:107], v[120:123], v[72:87]
    v_exp_f32 v58, v58
    v_exp_f32 v59, v59
    v_exp_f32 v60, v60
    v_exp_f32 v61, v61
    v_exp_f32 v62, v62
    v_exp_f32 v63, v63
    v_cvt_pk_bf16_f32 v124, v56, v57
    v_cvt_pk_bf16_f32 v125, v58, v59
    v_cvt_pk_bf16_f32 v126, v60, v61
    v_cvt_pk_bf16_f32 v127, v62, v63
    s_waitcnt lgkmcnt(0)
    s_nop 0
    v_mfma_f32_32x32x16_bf16 v[72:87], v[108:111], v[124:127], v[72:87]
    s_mov_b32 s45, 1166016512
    s_nop 15
    v_cmp_ngt_f32 vcc, s45, v80
    s_cmp_lg_u32 s40, 0
    s_cbranch_scc1 K2_OK
    s_cbranch_vccz K2_OK

    s_mov_b32 s40, 1
    v_mov_b32 v10, 0xff800000
    v_mov_b32 v11, v112
    s_mov_b32 s46, 0
    K2_MAXLOOP:
    ds_read_b128 v[88:91], v11
    s_waitcnt lgkmcnt(0)
    v_mfma_f32_32x32x16_bf16 v[32:47], v[88:91], v[4:7], 0
    s_nop 15

    v_max3_f32 v10, v10, v32, v33
    v_max3_f32 v10, v10, v34, v35
    v_max3_f32 v10, v10, v36, v37
    v_max3_f32 v10, v10, v38, v39
    v_max3_f32 v10, v10, v40, v41
    v_max3_f32 v10, v10, v42, v43
    v_max3_f32 v10, v10, v44, v45
    v_max3_f32 v10, v10, v46, v47
    v_add_u32 v11, 1024, v11
    s_add_u32 s46, s46, 1
    s_cmp_lt_u32 s46, 64
    s_cbranch_scc1 K2_MAXLOOP
    v_mov_b32 v11, v10
    s_nop 1
    v_permlane32_swap_b32 v10, v11
    s_nop 0
    v_max_f32 v10, v10, v11
    v_sub_f32 v10, 0, v10
    s_branch K2_RESTART
    K2_OK:

    v_lshrrev_b32 v12, 4, v0
    v_rcp_f32 v10, v80
    s_movk_i32 s29, 1040
    v_mul_lo_u32 v11, v2, s29
    v_lshl_add_u32 v11, v3, 5, v11
    v_lshl_add_u32 v11, v8, 3, v11
    v_add_u32 v11, s19, v11
    v_add_u32 v11, 131072, v11

    v_mul_f32 v72, v72, v10
    v_mul_f32 v73, v73, v10
    v_mul_f32 v74, v74, v10
    v_mul_f32 v75, v75, v10
    v_mul_f32 v76, v76, v10
    v_mul_f32 v77, v77, v10
    v_mul_f32 v78, v78, v10
    v_mul_f32 v79, v79, v10
    v_cvt_pk_bf16_f32 v72, v72, v73
    v_cvt_pk_bf16_f32 v73, v74, v75
    v_cvt_pk_bf16_f32 v74, v76, v77
    v_cvt_pk_bf16_f32 v75, v78, v79
    ds_write_b64 v11, v[72:73]
    ds_write_b64 v11, v[74:75] offset:16
    v_mul_lo_u32 v11, v2, s29
    v_lshl_add_u32 v11, v12, 4, v11
    v_add_u32 v11, 131072, v11
    v_lshl_add_u32 v1, v12, 3, v2
    v_lshlrev_b32 v1, 4, v1
    v_add_u32 v1, 141440, v1
    v_add_u32 v13, s16, v2
    v_lshlrev_b32 v13, 10, v13
    v_lshl_add_u32 v13, v12, 3, v13
    v_add_u32 v13, s19, v13
    v_and_b32 v9, 8, v0
    v_lshl_add_u32 v13, v9, 3, v13
    s_cmp_lt_u32 s18, 4
    s_cbranch_scc1 K2_PHB
    s_setprio 0
    s_sub_u32 s49, s18, 4

    s_lshl_b32 s28, s49, 17
    s_add_u32 s28, s28, 2240512
    s_lshl_b32 s47, s49, 12
    s_add_u32 s52, s14, s28
    s_addc_u32 s53, s15, 0

    s_add_u32 s54, s52, 16384
    s_addc_u32 s55, s53, 0
    s_add_u32 s56, s52, 32768
    s_addc_u32 s57, s53, 0
    s_add_u32 s58, s52, 49152
    s_addc_u32 s59, s53, 0
    s_add_u32 s60, s52, 65536
    s_addc_u32 s61, s53, 0
    s_add_u32 s62, s52, 81920
    s_addc_u32 s63, s53, 0
    s_add_u32 s64, s52, 98304
    s_addc_u32 s65, s53, 0
    s_add_u32 s66, s52, 114688
    s_addc_u32 s67, s53, 0
    s_waitcnt lgkmcnt(0)
    v_mov_b32 v9, 157824
    v_mov_b32 v10, 1
    ds_add_u32 v9, v10
    global_load_dwordx4 v[16:19], v112, s[52:53] offset:-4096
    global_load_dwordx4 v[20:23], v112, s[54:55] offset:-4096
    global_load_dwordx4 v[24:27], v112, s[56:57] offset:-4096
    global_load_dwordx4 v[28:31], v112, s[58:59] offset:-4096
    global_load_dwordx4 v[32:35], v112, s[60:61] offset:-4096
    global_load_dwordx4 v[36:39], v112, s[62:63] offset:-4096
    global_load_dwordx4 v[40:43], v112, s[64:65] offset:-4096
    global_load_dwordx4 v[44:47], v112, s[66:67] offset:-4096
    global_load_dwordx4 v[48:51], v112, s[52:53] offset:-3072
    global_load_dwordx4 v[52:55], v112, s[54:55] offset:-3072
    global_load_dwordx4 v[56:59], v112, s[56:57] offset:-3072
    global_load_dwordx4 v[60:63], v112, s[58:59] offset:-3072
    global_load_dwordx4 v[64:67], v112, s[60:61] offset:-3072
    global_load_dwordx4 v[68:71], v112, s[62:63] offset:-3072
    global_load_dwordx4 v[72:75], v112, s[64:65] offset:-3072
    global_load_dwordx4 v[76:79], v112, s[66:67] offset:-3072
    K2_SPIN:
    ds_read_b32 v10, v9
    s_waitcnt lgkmcnt(0)
    v_readfirstlane_b32 s49, v10
    s_cmp_ge_u32 s49, 256
    s_cbranch_scc1 K2_GO
    s_sleep 2
    s_branch K2_SPIN
    K2_GO:
    ds_read_b128 v[120:123], v11 offset:512
    ds_read_b128 v[124:127], v11 offset:576

    s_waitcnt vmcnt(8) lgkmcnt(1)
    v_mfma_f32_16x16x32_bf16 v[80:83], v[16:19], v[120:123], 0
    v_mfma_f32_16x16x32_bf16 v[84:87], v[20:23], v[120:123], 0
    v_mfma_f32_16x16x32_bf16 v[88:91], v[24:27], v[120:123], 0
    v_mfma_f32_16x16x32_bf16 v[92:95], v[28:31], v[120:123], 0
    v_mfma_f32_16x16x32_bf16 v[96:99], v[32:35], v[120:123], 0
    v_mfma_f32_16x16x32_bf16 v[100:103], v[36:39], v[120:123], 0
    v_mfma_f32_16x16x32_bf16 v[104:107], v[40:43], v[120:123], 0
    v_mfma_f32_16x16x32_bf16 v[108:111], v[44:47], v[120:123], 0
    ds_read_b128 v[120:123], v11 offset:640
    global_load_dwordx4 v[16:19], v112, s[52:53] offset:-2048
    global_load_dwordx4 v[20:23], v112, s[54:55] offset:-2048
    global_load_dwordx4 v[24:27], v112, s[56:57] offset:-2048
    global_load_dwordx4 v[28:31], v112, s[58:59] offset:-2048
    global_load_dwordx4 v[32:35], v112, s[60:61] offset:-2048
    global_load_dwordx4 v[36:39], v112, s[62:63] offset:-2048
    global_load_dwordx4 v[40:43], v112, s[64:65] offset:-2048
    global_load_dwordx4 v[44:47], v112, s[66:67] offset:-2048
    s_waitcnt vmcnt(8) lgkmcnt(1)
    v_mfma_f32_16x16x32_bf16 v[80:83], v[48:51], v[124:127], v[80:83]
    v_mfma_f32_16x16x32_bf16 v[84:87], v[52:55], v[124:127], v[84:87]
    v_mfma_f32_16x16x32_bf16 v[88:91], v[56:59], v[124:127], v[88:91]
    v_mfma_f32_16x16x32_bf16 v[92:95], v[60:63], v[124:127], v[92:95]
    v_mfma_f32_16x16x32_bf16 v[96:99], v[64:67], v[124:127], v[96:99]
    v_mfma_f32_16x16x32_bf16 v[100:103], v[68:71], v[124:127], v[100:103]
    v_mfma_f32_16x16x32_bf16 v[104:107], v[72:75], v[124:127], v[104:107]
    v_mfma_f32_16x16x32_bf16 v[108:111], v[76:79], v[124:127], v[108:111]
    ds_read_b128 v[124:127], v11 offset:704
    global_load_dwordx4 v[48:51], v112, s[52:53] offset:-1024
    global_load_dwordx4 v[52:55], v112, s[54:55] offset:-1024
    global_load_dwordx4 v[56:59], v112, s[56:57] offset:-1024
    global_load_dwordx4 v[60:63], v112, s[58:59] offset:-1024
    global_load_dwordx4 v[64:67], v112, s[60:61] offset:-1024
    global_load_dwordx4 v[68:71], v112, s[62:63] offset:-1024
    global_load_dwordx4 v[72:75], v112, s[64:65] offset:-1024
    global_load_dwordx4 v[76:79], v112, s[66:67] offset:-1024
    s_waitcnt vmcnt(8) lgkmcnt(1)
    v_mfma_f32_16x16x32_bf16 v[80:83], v[16:19], v[120:123], v[80:83]
    v_mfma_f32_16x16x32_bf16 v[84:87], v[20:23], v[120:123], v[84:87]
    v_mfma_f32_16x16x32_bf16 v[88:91], v[24:27], v[120:123], v[88:91]
    v_mfma_f32_16x16x32_bf16 v[92:95], v[28:31], v[120:123], v[92:95]
    v_mfma_f32_16x16x32_bf16 v[96:99], v[32:35], v[120:123], v[96:99]
    v_mfma_f32_16x16x32_bf16 v[100:103], v[36:39], v[120:123], v[100:103]
    v_mfma_f32_16x16x32_bf16 v[104:107], v[40:43], v[120:123], v[104:107]
    v_mfma_f32_16x16x32_bf16 v[108:111], v[44:47], v[120:123], v[108:111]
    ds_read_b128 v[120:123], v11 offset:768
    global_load_dwordx4 v[16:19], v112, s[52:53] offset:0
    global_load_dwordx4 v[20:23], v112, s[54:55] offset:0
    global_load_dwordx4 v[24:27], v112, s[56:57] offset:0
    global_load_dwordx4 v[28:31], v112, s[58:59] offset:0
    global_load_dwordx4 v[32:35], v112, s[60:61] offset:0
    global_load_dwordx4 v[36:39], v112, s[62:63] offset:0
    global_load_dwordx4 v[40:43], v112, s[64:65] offset:0
    global_load_dwordx4 v[44:47], v112, s[66:67] offset:0
    s_waitcnt vmcnt(8) lgkmcnt(1)
    v_mfma_f32_16x16x32_bf16 v[80:83], v[48:51], v[124:127], v[80:83]
    v_mfma_f32_16x16x32_bf16 v[84:87], v[52:55], v[124:127], v[84:87]
    v_mfma_f32_16x16x32_bf16 v[88:91], v[56:59], v[124:127], v[88:91]
    v_mfma_f32_16x16x32_bf16 v[92:95], v[60:63], v[124:127], v[92:95]
    v_mfma_f32_16x16x32_bf16 v[96:99], v[64:67], v[124:127], v[96:99]
    v_mfma_f32_16x16x32_bf16 v[100:103], v[68:71], v[124:127], v[100:103]
    v_mfma_f32_16x16x32_bf16 v[104:107], v[72:75], v[124:127], v[104:107]
    v_mfma_f32_16x16x32_bf16 v[108:111], v[76:79], v[124:127], v[108:111]
    ds_read_b128 v[124:127], v11 offset:832
    global_load_dwordx4 v[48:51], v112, s[52:53] offset:1024
    global_load_dwordx4 v[52:55], v112, s[54:55] offset:1024
    global_load_dwordx4 v[56:59], v112, s[56:57] offset:1024
    global_load_dwordx4 v[60:63], v112, s[58:59] offset:1024
    global_load_dwordx4 v[64:67], v112, s[60:61] offset:1024
    global_load_dwordx4 v[68:71], v112, s[62:63] offset:1024
    global_load_dwordx4 v[72:75], v112, s[64:65] offset:1024
    global_load_dwordx4 v[76:79], v112, s[66:67] offset:1024
    s_waitcnt vmcnt(8) lgkmcnt(1)
    v_mfma_f32_16x16x32_bf16 v[80:83], v[16:19], v[120:123], v[80:83]
    v_mfma_f32_16x16x32_bf16 v[84:87], v[20:23], v[120:123], v[84:87]
    v_mfma_f32_16x16x32_bf16 v[88:91], v[24:27], v[120:123], v[88:91]
    v_mfma_f32_16x16x32_bf16 v[92:95], v[28:31], v[120:123], v[92:95]
    v_mfma_f32_16x16x32_bf16 v[96:99], v[32:35], v[120:123], v[96:99]
    v_mfma_f32_16x16x32_bf16 v[100:103], v[36:39], v[120:123], v[100:103]
    v_mfma_f32_16x16x32_bf16 v[104:107], v[40:43], v[120:123], v[104:107]
    v_mfma_f32_16x16x32_bf16 v[108:111], v[44:47], v[120:123], v[108:111]
    ds_read_b128 v[120:123], v11 offset:896
    global_load_dwordx4 v[16:19], v112, s[52:53] offset:2048
    global_load_dwordx4 v[20:23], v112, s[54:55] offset:2048
    global_load_dwordx4 v[24:27], v112, s[56:57] offset:2048
    global_load_dwordx4 v[28:31], v112, s[58:59] offset:2048
    global_load_dwordx4 v[32:35], v112, s[60:61] offset:2048
    global_load_dwordx4 v[36:39], v112, s[62:63] offset:2048
    global_load_dwordx4 v[40:43], v112, s[64:65] offset:2048
    global_load_dwordx4 v[44:47], v112, s[66:67] offset:2048
    s_waitcnt vmcnt(8) lgkmcnt(1)
    v_mfma_f32_16x16x32_bf16 v[80:83], v[48:51], v[124:127], v[80:83]
    v_mfma_f32_16x16x32_bf16 v[84:87], v[52:55], v[124:127], v[84:87]
    v_mfma_f32_16x16x32_bf16 v[88:91], v[56:59], v[124:127], v[88:91]
    v_mfma_f32_16x16x32_bf16 v[92:95], v[60:63], v[124:127], v[92:95]
    v_mfma_f32_16x16x32_bf16 v[96:99], v[64:67], v[124:127], v[96:99]
    v_mfma_f32_16x16x32_bf16 v[100:103], v[68:71], v[124:127], v[100:103]
    v_mfma_f32_16x16x32_bf16 v[104:107], v[72:75], v[124:127], v[104:107]
    v_mfma_f32_16x16x32_bf16 v[108:111], v[76:79], v[124:127], v[108:111]
    ds_read_b128 v[124:127], v11 offset:960
    global_load_dwordx4 v[48:51], v112, s[52:53] offset:3072
    global_load_dwordx4 v[52:55], v112, s[54:55] offset:3072
    global_load_dwordx4 v[56:59], v112, s[56:57] offset:3072
    global_load_dwordx4 v[60:63], v112, s[58:59] offset:3072
    global_load_dwordx4 v[64:67], v112, s[60:61] offset:3072
    global_load_dwordx4 v[68:71], v112, s[62:63] offset:3072
    global_load_dwordx4 v[72:75], v112, s[64:65] offset:3072
    global_load_dwordx4 v[76:79], v112, s[66:67] offset:3072
    s_waitcnt vmcnt(8) lgkmcnt(1)
    v_mfma_f32_16x16x32_bf16 v[80:83], v[16:19], v[120:123], v[80:83]
    v_mfma_f32_16x16x32_bf16 v[84:87], v[20:23], v[120:123], v[84:87]
    v_mfma_f32_16x16x32_bf16 v[88:91], v[24:27], v[120:123], v[88:91]
    v_mfma_f32_16x16x32_bf16 v[92:95], v[28:31], v[120:123], v[92:95]
    v_mfma_f32_16x16x32_bf16 v[96:99], v[32:35], v[120:123], v[96:99]
    v_mfma_f32_16x16x32_bf16 v[100:103], v[36:39], v[120:123], v[100:103]
    v_mfma_f32_16x16x32_bf16 v[104:107], v[40:43], v[120:123], v[104:107]
    v_mfma_f32_16x16x32_bf16 v[108:111], v[44:47], v[120:123], v[108:111]
    s_waitcnt vmcnt(0) lgkmcnt(0)
    v_mfma_f32_16x16x32_bf16 v[80:83], v[48:51], v[124:127], v[80:83]
    v_mfma_f32_16x16x32_bf16 v[84:87], v[52:55], v[124:127], v[84:87]
    v_mfma_f32_16x16x32_bf16 v[88:91], v[56:59], v[124:127], v[88:91]
    v_mfma_f32_16x16x32_bf16 v[92:95], v[60:63], v[124:127], v[92:95]
    v_mfma_f32_16x16x32_bf16 v[96:99], v[64:67], v[124:127], v[96:99]
    v_mfma_f32_16x16x32_bf16 v[100:103], v[68:71], v[124:127], v[100:103]
    v_mfma_f32_16x16x32_bf16 v[104:107], v[72:75], v[124:127], v[104:107]
    v_mfma_f32_16x16x32_bf16 v[108:111], v[76:79], v[124:127], v[108:111]
    v_add_u32 v9, s47, v1
    s_mov_b32 s44, 0x00ff00ff
    s_mov_b32 s45, 0x00ff00ff
    s_nop 4
    s_mov_b64 exec, s[44:45]

    ds_write_b128 v9, v[80:83] offset:0
    ds_write_b128 v9, v[84:87] offset:512
    ds_write_b128 v9, v[88:91] offset:1024
    ds_write_b128 v9, v[92:95] offset:1536
    ds_write_b128 v9, v[96:99] offset:2048
    ds_write_b128 v9, v[100:103] offset:2560
    ds_write_b128 v9, v[104:107] offset:3072
    ds_write_b128 v9, v[108:111] offset:3584
    s_mov_b64 exec, -1
K2_PHB:
    global_load_dwordx2 v[122:123], v13, s[4:5]
    global_load_dwordx2 v[124:125], v13, s[4:5] offset:32
    s_lshl_b32 s28, s18, 11
    v_add_u32 v9, s28, v1
    s_waitcnt lgkmcnt(0)
    s_barrier

    ds_read_b128 v[72:75], v9 offset:0
    ds_read_b128 v[76:79], v9 offset:512
    ds_read_b128 v[80:83], v9 offset:1024
    ds_read_b128 v[84:87], v9 offset:1536
    ds_read_b128 v[96:99], v11 offset:0
    ds_read_b128 v[100:103], v11 offset:64
    ds_read_b128 v[104:107], v11 offset:128
    ds_read_b128 v[108:111], v11 offset:192
    s_waitcnt vmcnt(2)
    s_waitcnt lgkmcnt(3)
    v_mfma_f32_16x16x32_bf16 v[72:75], v[128:131], v[96:99], v[72:75]
    v_mfma_f32_16x16x32_bf16 v[76:79], v[132:135], v[96:99], v[76:79]
    v_mfma_f32_16x16x32_bf16 v[80:83], v[136:139], v[96:99], v[80:83]
    v_mfma_f32_16x16x32_bf16 v[84:87], v[140:143], v[96:99], v[84:87]
    ds_read_b128 v[96:99], v11 offset:256
    s_waitcnt lgkmcnt(3)
    v_mfma_f32_16x16x32_bf16 v[72:75], v[144:147], v[100:103], v[72:75]
    v_mfma_f32_16x16x32_bf16 v[76:79], v[148:151], v[100:103], v[76:79]
    v_mfma_f32_16x16x32_bf16 v[80:83], v[152:155], v[100:103], v[80:83]
    v_mfma_f32_16x16x32_bf16 v[84:87], v[156:159], v[100:103], v[84:87]
    ds_read_b128 v[100:103], v11 offset:320
    s_waitcnt lgkmcnt(3)
    v_mfma_f32_16x16x32_bf16 v[72:75], v[160:163], v[104:107], v[72:75]
    v_mfma_f32_16x16x32_bf16 v[76:79], v[164:167], v[104:107], v[76:79]
    v_mfma_f32_16x16x32_bf16 v[80:83], v[168:171], v[104:107], v[80:83]
    v_mfma_f32_16x16x32_bf16 v[84:87], v[172:175], v[104:107], v[84:87]
    ds_read_b128 v[104:107], v11 offset:384
    s_waitcnt lgkmcnt(3)
    v_mfma_f32_16x16x32_bf16 v[72:75], v[176:179], v[108:111], v[72:75]
    v_mfma_f32_16x16x32_bf16 v[76:79], v[180:183], v[108:111], v[76:79]
    v_mfma_f32_16x16x32_bf16 v[80:83], v[184:187], v[108:111], v[80:83]
    v_mfma_f32_16x16x32_bf16 v[84:87], v[188:191], v[108:111], v[84:87]
    ds_read_b128 v[108:111], v11 offset:448
    s_waitcnt lgkmcnt(3)
    v_mfma_f32_16x16x32_bf16 v[72:75], v[192:195], v[96:99], v[72:75]
    v_mfma_f32_16x16x32_bf16 v[76:79], v[196:199], v[96:99], v[76:79]
    v_mfma_f32_16x16x32_bf16 v[80:83], v[200:203], v[96:99], v[80:83]
    v_mfma_f32_16x16x32_bf16 v[84:87], v[204:207], v[96:99], v[84:87]
    s_waitcnt lgkmcnt(2)
    v_mfma_f32_16x16x32_bf16 v[72:75], v[208:211], v[100:103], v[72:75]
    v_mfma_f32_16x16x32_bf16 v[76:79], v[212:215], v[100:103], v[76:79]
    v_mfma_f32_16x16x32_bf16 v[80:83], v[216:219], v[100:103], v[80:83]
    v_mfma_f32_16x16x32_bf16 v[84:87], v[220:223], v[100:103], v[84:87]
    s_waitcnt lgkmcnt(1)
    v_mfma_f32_16x16x32_bf16 v[72:75], v[224:227], v[104:107], v[72:75]
    v_mfma_f32_16x16x32_bf16 v[76:79], v[228:231], v[104:107], v[76:79]
    v_mfma_f32_16x16x32_bf16 v[80:83], v[232:235], v[104:107], v[80:83]
    v_mfma_f32_16x16x32_bf16 v[84:87], v[236:239], v[104:107], v[84:87]
    s_waitcnt lgkmcnt(0)
    v_mfma_f32_16x16x32_bf16 v[72:75], v[240:243], v[108:111], v[72:75]
    v_mfma_f32_16x16x32_bf16 v[76:79], v[244:247], v[108:111], v[76:79]
    v_mfma_f32_16x16x32_bf16 v[80:83], v[248:251], v[108:111], v[80:83]
    v_mfma_f32_16x16x32_bf16 v[84:87], v[252:255], v[108:111], v[84:87]
    s_waitcnt vmcnt(0)
    s_mov_b32 s33, 0xffff0000
    s_mov_b32 s44, 0xff00ff00
    s_mov_b32 s45, 0xff00ff00
    s_nop 5

    v_cndmask_b32 v88, v72, v80, s[44:45]
    v_cndmask_b32 v89, v73, v81, s[44:45]
    v_cndmask_b32 v90, v74, v82, s[44:45]
    v_cndmask_b32 v91, v75, v83, s[44:45]
    v_cndmask_b32 v92, v76, v84, s[44:45]
    v_cndmask_b32 v93, v77, v85, s[44:45]
    v_cndmask_b32 v94, v78, v86, s[44:45]
    v_cndmask_b32 v95, v79, v87, s[44:45]
    v_cvt_pk_bf16_f32 v40, v88, v89
    v_lshlrev_b32 v41, 16, v40
    v_and_b32 v42, s33, v40
    v_lshlrev_b32 v43, 16, v122
    v_and_b32 v44, s33, v122
    v_cvt_pk_bf16_f32 v46, v90, v91
    v_lshlrev_b32 v47, 16, v46
    v_and_b32 v48, s33, v46
    v_lshlrev_b32 v49, 16, v123
    v_and_b32 v50, s33, v123
    v_cvt_pk_bf16_f32 v52, v92, v93
    v_lshlrev_b32 v53, 16, v52
    v_and_b32 v54, s33, v52
    v_lshlrev_b32 v55, 16, v124
    v_and_b32 v56, s33, v124
    v_cvt_pk_bf16_f32 v58, v94, v95
    v_lshlrev_b32 v59, 16, v58
    v_and_b32 v60, s33, v58
    v_lshlrev_b32 v61, 16, v125
    v_and_b32 v62, s33, v125
    v_add_f32 v41, v41, v43
    v_add_f32 v42, v42, v44
    v_add_f32 v47, v47, v49
    v_add_f32 v48, v48, v50
    v_add_f32 v53, v53, v55
    v_add_f32 v54, v54, v56
    v_add_f32 v59, v59, v61
    v_add_f32 v60, v60, v62
    v_cvt_pk_bf16_f32 v32, v41, v42
    v_cvt_pk_bf16_f32 v33, v47, v48
    v_cvt_pk_bf16_f32 v34, v53, v54
    v_cvt_pk_bf16_f32 v35, v59, v60
    v_lshlrev_b32 v16, 16, v32
    v_and_b32 v17, s33, v32
    v_lshlrev_b32 v18, 16, v33
    v_and_b32 v19, s33, v33
    v_lshlrev_b32 v20, 16, v34
    v_and_b32 v21, s33, v34
    v_lshlrev_b32 v22, 16, v35
    v_and_b32 v23, s33, v35
    v_pk_add_f32 v[40:41], v[16:17], v[18:19]
    v_pk_add_f32 v[42:43], v[20:21], v[22:23]
    v_pk_add_f32 v[40:41], v[40:41], v[42:43]
    v_add_f32 v40, v40, v41

    s_nop 1
    v_add_f32_dpp v40, v40, v40 row_ror:8 row_mask:0xf bank_mask:0xf
    v_mov_b32 v41, v40
    s_nop 1
    v_permlane16_swap_b32 v40, v41
    s_nop 0
    v_add_f32 v40, v40, v41
    v_mov_b32 v41, v40
    s_nop 1
    v_permlane32_swap_b32 v40, v41
    s_nop 0
    v_add_f32 v40, v40, v41
    v_mul_f32 v42, 1015021568, v40
    v_mov_b32 v43, v42

    v_pk_add_f32 v[48:49], v[16:17], v[42:43] neg_lo:[0,1] neg_hi:[0,1]
    v_pk_add_f32 v[50:51], v[18:19], v[42:43] neg_lo:[0,1] neg_hi:[0,1]
    v_pk_add_f32 v[52:53], v[20:21], v[42:43] neg_lo:[0,1] neg_hi:[0,1]
    v_pk_add_f32 v[54:55], v[22:23], v[42:43] neg_lo:[0,1] neg_hi:[0,1]
    v_pk_mul_f32 v[44:45], v[48:49], v[48:49]
    v_pk_mul_f32 v[46:47], v[50:51], v[50:51]
    v_pk_fma_f32 v[44:45], v[52:53], v[52:53], v[44:45]
    v_pk_fma_f32 v[46:47], v[54:55], v[54:55], v[46:47]
    v_pk_add_f32 v[44:45], v[44:45], v[46:47]
    v_add_f32 v41, v44, v45
    s_nop 1
    v_add_f32_dpp v41, v41, v41 row_ror:8 row_mask:0xf bank_mask:0xf
    v_mov_b32 v44, v41
    s_nop 1
    v_permlane16_swap_b32 v41, v44
    s_nop 0
    v_add_f32 v41, v41, v44
    v_mov_b32 v44, v41
    s_nop 1
    v_permlane32_swap_b32 v41, v44
    s_nop 0
    v_add_f32 v41, v41, v44
    v_lshlrev_b32 v46, 6, v2
    v_add_u32 v46, 139392, v46
    s_lshl_b32 s28, s18, 3
    v_add_u32 v45, s28, v46
    ds_write_b64 v45, v[40:41]
    s_mov_b32 s34, 989855744
    s_mov_b32 s35, 925353388
    v_add_u32 v14, 3145728, v13
    v_add_u32 v36, s16, v2
    v_and_b32 v37, 127, v36
    v_lshrrev_b32 v36, 7, v36
    v_lshlrev_b32 v36, 4, v36
    v_bfe_u32 v38, v0, 3, 1
    v_add_u32 v36, v36, v38
    s_lshl_b32 s28, s18, 1
    v_add_u32 v36, s28, v36
    v_lshlrev_b32 v36, 13, v36
    v_lshl_add_u32 v36, v37, 6, v36
    v_bfe_u32 v37, v37, 2, 2
    v_lshrrev_b32 v38, 1, v12
    v_xor_b32 v37, v37, v38
    v_lshl_add_u32 v36, v37, 4, v36
    v_and_b32 v38, 1, v12
    v_lshl_add_u32 v36, v38, 3, v36
    v_add_u32 v15, 5242880, v36
    v_xor_b32 v36, 32, v36
    v_add_u32 v36, 5242880, v36
    global_store_dwordx2 v14, v[32:33], s[14:15]
    global_store_dwordx2 v14, v[34:35], s[14:15] offset:32
    s_waitcnt lgkmcnt(0)
    s_barrier
    ds_read_b128 v[48:51], v46
    ds_read_b128 v[52:55], v46 offset:16
    ds_read_b128 v[56:59], v46 offset:32
    ds_read_b128 v[60:63], v46 offset:48
    s_waitcnt lgkmcnt(0)
    v_pk_add_f32 v[64:65], v[48:49], v[50:51]
    v_pk_add_f32 v[66:67], v[52:53], v[54:55]
    v_pk_add_f32 v[68:69], v[56:57], v[58:59]
    v_pk_add_f32 v[70:71], v[60:61], v[62:63]
    v_pk_add_f32 v[64:65], v[64:65], v[66:67]
    v_pk_add_f32 v[68:69], v[68:69], v[70:71]
    v_pk_add_f32 v[64:65], v[64:65], v[68:69]
    v_mul_f32 v40, s34, v64
    v_mul_f32 v44, 64.0, v40

    v_sub_f32 v66, v48, v44
    v_sub_f32 v67, v50, v44
    v_sub_f32 v68, v52, v44
    v_sub_f32 v69, v54, v44
    v_sub_f32 v70, v56, v44
    v_sub_f32 v71, v58, v44
    v_sub_f32 v72, v60, v44
    v_sub_f32 v73, v62, v44
    v_mul_f32 v43, v66, v66
    v_mul_f32 v45, v67, v67
    v_fmac_f32 v43, v68, v68
    v_fmac_f32 v45, v69, v69
    v_fmac_f32 v43, v70, v70
    v_fmac_f32 v45, v71, v71
    v_fmac_f32 v43, v72, v72
    v_fmac_f32 v45, v73, v73
    v_add_f32 v43, v43, v45
    v_fmac_f32 v65, 1015021568, v43
    v_mul_f32 v43, s34, v65
    v_cvt_pk_bf16_f32 v41, v40, v40
    v_lshlrev_b32 v41, 16, v41
    v_max_f32 v43, 0, v43
    v_cvt_pk_bf16_f32 v43, v43, v43
    v_lshlrev_b32 v43, 16, v43
    v_add_f32 v43, s35, v43
    v_cvt_pk_bf16_f32 v43, v43, v43
    v_lshlrev_b32 v43, 16, v43
    v_sqrt_f32 v43, v43
    s_nop 0
    v_cvt_pk_bf16_f32 v43, v43, v43
    v_lshlrev_b32 v43, 16, v43
    v_rcp_f32 v43, v43

    v_sub_f32 v16, v16, v41
    v_sub_f32 v17, v17, v41
    v_sub_f32 v18, v18, v41
    v_sub_f32 v19, v19, v41
    v_sub_f32 v20, v20, v41
    v_sub_f32 v21, v21, v41
    v_sub_f32 v22, v22, v41
    v_sub_f32 v23, v23, v41
    v_mul_f32 v16, v16, v43
    v_mul_f32 v17, v17, v43
    v_mul_f32 v18, v18, v43
    v_mul_f32 v19, v19, v43
    v_mul_f32 v20, v20, v43
    v_mul_f32 v21, v21, v43
    v_mul_f32 v22, v22, v43
    v_mul_f32 v23, v23, v43
    v_cvt_pk_bf16_f32 v48, v16, v17
    v_cvt_pk_bf16_f32 v49, v18, v19
    v_cvt_pk_bf16_f32 v50, v20, v21
    v_cvt_pk_bf16_f32 v51, v22, v23
    global_store_dwordx2 v15, v[48:49], s[14:15]
    global_store_dwordx2 v36, v[50:51], s[14:15]

K2_END:
    s_endpgm
.globl k3_ffn_up_kernel
.p2align 8
.type k3_ffn_up_kernel,@function
k3_ffn_up_kernel:
    s_cmp_ge_u32 s2, 224
    s_cbranch_scc1 K3_END
    s_load_dwordx4 s[4:7], s[0:1], 48
    s_load_dwordx2 s[14:15], s[0:1], 88
    v_lshrrev_b32 v1, 6, v0
    v_and_b32 v0, 63, v0
    s_and_b32 s19, s2, 7
    s_lshr_b32 s17, s2, 3
    s_mul_i32 s16, s17, 37
    s_lshr_b32 s16, s16, 8
    s_mul_i32 s34, s16, 7
    s_sub_u32 s17, s17, s34
    s_lshr_b32 s34, s19, 1
    s_lshl_b32 s34, s34, 2
    s_add_u32 s16, s16, s34
    s_and_b32 s19, s19, 1
    s_mul_i32 s19, s19, 7
    s_add_u32 s17, s17, s19
    v_readfirstlane_b32 s18, v1
    v_lshrrev_b32 v2, 4, v0
    v_and_b32 v3, 15, v0
    s_movk_i32 s33, 3584
    s_waitcnt lgkmcnt(0)

    s_cmp_lt_u32 s18, 8
    s_cbranch_scc1 K3_CONS
    s_add_u32 s20, s14, 5242880
    s_addc_u32 s21, s15, 0
    s_mov_b32 s22, 2097152
    s_mov_b32 s23, 0x00020000
    s_mov_b32 s24, s4
    s_mov_b32 s25, s5
    s_mov_b32 s26, 1835008
    s_mov_b32 s27, 0x00020000
    s_mov_b32 s28, s6
    s_mov_b32 s29, s7
    s_mov_b32 s30, 1835008
    s_mov_b32 s31, 0x00020000
    s_sub_u32 s19, s18, 8
    v_lshlrev_b32 v6, 4, v0
    v_lshlrev_b32 v8, 2, v2
    v_xor_b32 v8, v3, v8
    v_lshlrev_b32 v8, 4, v8
    v_mul_lo_u32 v9, v2, s33
    v_add_u32 v8, v8, v9
    s_lshl_b32 s34, s16, 17
    s_lshl_b32 s35, s19, 11
    s_add_u32 s34, s34, s35
    s_mul_i32 s35, s19, 28672
    s_lshl_b32 s36, s17, 8
    s_add_u32 s35, s35, s36
    s_lshl_b32 s36, s19, 11

    s_add_u32 m0, s36, 0
    s_add_u32 s38, s34, 0
    buffer_load_dwordx4 v6, s[20:23], s38 offen lds
    s_add_u32 m0, s36, 8192
    s_add_u32 s39, s35, 0
    buffer_load_dwordx4 v8, s[24:27], s39 offen lds
    s_add_u32 m0, s36, 16384
    s_nop 0
    buffer_load_dwordx4 v8, s[28:31], s39 offen lds
    s_add_u32 m0, s36, 1024
    s_add_u32 s38, s34, 1024
    buffer_load_dwordx4 v6, s[20:23], s38 offen lds
    s_add_u32 m0, s36, 9216
    s_add_u32 s39, s35, 14336
    buffer_load_dwordx4 v8, s[24:27], s39 offen lds
    s_add_u32 m0, s36, 17408
    s_nop 0
    buffer_load_dwordx4 v8, s[28:31], s39 offen lds
    s_add_u32 m0, s36, 24576
    s_add_u32 s38, s34, 8192
    buffer_load_dwordx4 v6, s[20:23], s38 offen lds
    s_add_u32 m0, s36, 32768
    s_add_u32 s39, s35, 114688
    buffer_load_dwordx4 v8, s[24:27], s39 offen lds
    s_add_u32 m0, s36, 40960
    s_nop 0
    buffer_load_dwordx4 v8, s[28:31], s39 offen lds
    s_add_u32 m0, s36, 25600
    s_add_u32 s38, s34, 9216
    buffer_load_dwordx4 v6, s[20:23], s38 offen lds
    s_add_u32 m0, s36, 33792
    s_add_u32 s39, s35, 129024
    buffer_load_dwordx4 v8, s[24:27], s39 offen lds
    s_add_u32 m0, s36, 41984
    s_nop 0
    buffer_load_dwordx4 v8, s[28:31], s39 offen lds
    s_add_u32 m0, s36, 49152
    s_add_u32 s38, s34, 16384
    buffer_load_dwordx4 v6, s[20:23], s38 offen lds
    s_add_u32 m0, s36, 57344
    s_add_u32 s39, s35, 229376
    buffer_load_dwordx4 v8, s[24:27], s39 offen lds
    s_add_u32 m0, s36, 65536
    s_nop 0
    buffer_load_dwordx4 v8, s[28:31], s39 offen lds
    s_add_u32 m0, s36, 50176
    s_add_u32 s38, s34, 17408
    buffer_load_dwordx4 v6, s[20:23], s38 offen lds
    s_add_u32 m0, s36, 58368
    s_add_u32 s39, s35, 243712
    buffer_load_dwordx4 v8, s[24:27], s39 offen lds
    s_add_u32 m0, s36, 66560
    s_nop 0
    buffer_load_dwordx4 v8, s[28:31], s39 offen lds
    s_waitcnt vmcnt(6)
    s_barrier
    s_add_u32 m0, s36, 73728
    s_add_u32 s38, s34, 24576
    buffer_load_dwordx4 v6, s[20:23], s38 offen lds
    s_add_u32 m0, s36, 81920
    s_add_u32 s39, s35, 344064
    buffer_load_dwordx4 v8, s[24:27], s39 offen lds
    s_add_u32 m0, s36, 90112
    s_nop 0
    buffer_load_dwordx4 v8, s[28:31], s39 offen lds
    s_add_u32 m0, s36, 74752
    s_add_u32 s38, s34, 25600
    buffer_load_dwordx4 v6, s[20:23], s38 offen lds
    s_add_u32 m0, s36, 82944
    s_add_u32 s39, s35, 358400
    buffer_load_dwordx4 v8, s[24:27], s39 offen lds
    s_add_u32 m0, s36, 91136
    s_nop 0
    buffer_load_dwordx4 v8, s[28:31], s39 offen lds
    s_add_u32 m0, s36, 98304
    s_add_u32 s38, s34, 32768
    buffer_load_dwordx4 v6, s[20:23], s38 offen lds
    s_add_u32 m0, s36, 106496
    s_add_u32 s39, s35, 458752
    buffer_load_dwordx4 v8, s[24:27], s39 offen lds
    s_add_u32 m0, s36, 114688
    s_nop 0
    buffer_load_dwordx4 v8, s[28:31], s39 offen lds
    s_add_u32 m0, s36, 99328
    s_add_u32 s38, s34, 33792
    buffer_load_dwordx4 v6, s[20:23], s38 offen lds
    s_add_u32 m0, s36, 107520
    s_add_u32 s39, s35, 473088
    buffer_load_dwordx4 v8, s[24:27], s39 offen lds
    s_add_u32 m0, s36, 115712
    s_nop 0
    buffer_load_dwordx4 v8, s[28:31], s39 offen lds
    s_waitcnt vmcnt(12)
    s_barrier
    s_add_u32 m0, s36, 122880
    s_add_u32 s38, s34, 40960
    buffer_load_dwordx4 v6, s[20:23], s38 offen lds
    s_add_u32 m0, s36, 131072
    s_add_u32 s39, s35, 573440
    buffer_load_dwordx4 v8, s[24:27], s39 offen lds
    s_add_u32 m0, s36, 139264
    s_nop 0
    buffer_load_dwordx4 v8, s[28:31], s39 offen lds
    s_add_u32 m0, s36, 123904
    s_add_u32 s38, s34, 41984
    buffer_load_dwordx4 v6, s[20:23], s38 offen lds
    s_add_u32 m0, s36, 132096
    s_add_u32 s39, s35, 587776
    buffer_load_dwordx4 v8, s[24:27], s39 offen lds
    s_add_u32 m0, s36, 140288
    s_nop 0
    buffer_load_dwordx4 v8, s[28:31], s39 offen lds
    s_add_u32 m0, s36, 0
    s_add_u32 s38, s34, 49152
    buffer_load_dwordx4 v6, s[20:23], s38 offen lds
    s_add_u32 m0, s36, 8192
    s_add_u32 s39, s35, 688128
    buffer_load_dwordx4 v8, s[24:27], s39 offen lds
    s_add_u32 m0, s36, 16384
    s_nop 0
    buffer_load_dwordx4 v8, s[28:31], s39 offen lds
    s_add_u32 m0, s36, 1024
    s_add_u32 s38, s34, 50176
    buffer_load_dwordx4 v6, s[20:23], s38 offen lds
    s_add_u32 m0, s36, 9216
    s_add_u32 s39, s35, 702464
    buffer_load_dwordx4 v8, s[24:27], s39 offen lds
    s_add_u32 m0, s36, 17408
    s_nop 0
    buffer_load_dwordx4 v8, s[28:31], s39 offen lds
    s_waitcnt vmcnt(18)
    s_barrier
    s_add_u32 m0, s36, 24576
    s_add_u32 s38, s34, 57344
    buffer_load_dwordx4 v6, s[20:23], s38 offen lds
    s_add_u32 m0, s36, 32768
    s_add_u32 s39, s35, 802816
    buffer_load_dwordx4 v8, s[24:27], s39 offen lds
    s_add_u32 m0, s36, 40960
    s_nop 0
    buffer_load_dwordx4 v8, s[28:31], s39 offen lds
    s_add_u32 m0, s36, 25600
    s_add_u32 s38, s34, 58368
    buffer_load_dwordx4 v6, s[20:23], s38 offen lds
    s_add_u32 m0, s36, 33792
    s_add_u32 s39, s35, 817152
    buffer_load_dwordx4 v8, s[24:27], s39 offen lds
    s_add_u32 m0, s36, 41984
    s_nop 0
    buffer_load_dwordx4 v8, s[28:31], s39 offen lds
    s_waitcnt vmcnt(18)
    s_barrier
    s_add_u32 m0, s36, 49152
    s_add_u32 s38, s34, 65536
    buffer_load_dwordx4 v6, s[20:23], s38 offen lds
    s_add_u32 m0, s36, 57344
    s_add_u32 s39, s35, 917504
    buffer_load_dwordx4 v8, s[24:27], s39 offen lds
    s_add_u32 m0, s36, 65536
    s_nop 0
    buffer_load_dwordx4 v8, s[28:31], s39 offen lds
    s_add_u32 m0, s36, 50176
    s_add_u32 s38, s34, 66560
    buffer_load_dwordx4 v6, s[20:23], s38 offen lds
    s_add_u32 m0, s36, 58368
    s_add_u32 s39, s35, 931840
    buffer_load_dwordx4 v8, s[24:27], s39 offen lds
    s_add_u32 m0, s36, 66560
    s_nop 0
    buffer_load_dwordx4 v8, s[28:31], s39 offen lds
    s_waitcnt vmcnt(18)
    s_barrier
    s_add_u32 m0, s36, 73728
    s_add_u32 s38, s34, 73728
    buffer_load_dwordx4 v6, s[20:23], s38 offen lds
    s_add_u32 m0, s36, 81920
    s_add_u32 s39, s35, 1032192
    buffer_load_dwordx4 v8, s[24:27], s39 offen lds
    s_add_u32 m0, s36, 90112
    s_nop 0
    buffer_load_dwordx4 v8, s[28:31], s39 offen lds
    s_add_u32 m0, s36, 74752
    s_add_u32 s38, s34, 74752
    buffer_load_dwordx4 v6, s[20:23], s38 offen lds
    s_add_u32 m0, s36, 82944
    s_add_u32 s39, s35, 1046528
    buffer_load_dwordx4 v8, s[24:27], s39 offen lds
    s_add_u32 m0, s36, 91136
    s_nop 0
    buffer_load_dwordx4 v8, s[28:31], s39 offen lds
    s_waitcnt vmcnt(18)
    s_barrier
    s_add_u32 m0, s36, 98304
    s_add_u32 s38, s34, 81920
    buffer_load_dwordx4 v6, s[20:23], s38 offen lds
    s_add_u32 m0, s36, 106496
    s_add_u32 s39, s35, 1146880
    buffer_load_dwordx4 v8, s[24:27], s39 offen lds
    s_add_u32 m0, s36, 114688
    s_nop 0
    buffer_load_dwordx4 v8, s[28:31], s39 offen lds
    s_add_u32 m0, s36, 99328
    s_add_u32 s38, s34, 82944
    buffer_load_dwordx4 v6, s[20:23], s38 offen lds
    s_add_u32 m0, s36, 107520
    s_add_u32 s39, s35, 1161216
    buffer_load_dwordx4 v8, s[24:27], s39 offen lds
    s_add_u32 m0, s36, 115712
    s_nop 0
    buffer_load_dwordx4 v8, s[28:31], s39 offen lds
    s_waitcnt vmcnt(18)
    s_barrier
    s_add_u32 m0, s36, 122880
    s_add_u32 s38, s34, 90112
    buffer_load_dwordx4 v6, s[20:23], s38 offen lds
    s_add_u32 m0, s36, 131072
    s_add_u32 s39, s35, 1261568
    buffer_load_dwordx4 v8, s[24:27], s39 offen lds
    s_add_u32 m0, s36, 139264
    s_nop 0
    buffer_load_dwordx4 v8, s[28:31], s39 offen lds
    s_add_u32 m0, s36, 123904
    s_add_u32 s38, s34, 91136
    buffer_load_dwordx4 v6, s[20:23], s38 offen lds
    s_add_u32 m0, s36, 132096
    s_add_u32 s39, s35, 1275904
    buffer_load_dwordx4 v8, s[24:27], s39 offen lds
    s_add_u32 m0, s36, 140288
    s_nop 0
    buffer_load_dwordx4 v8, s[28:31], s39 offen lds
    s_waitcnt vmcnt(18)
    s_barrier
    s_add_u32 m0, s36, 0
    s_add_u32 s38, s34, 98304
    buffer_load_dwordx4 v6, s[20:23], s38 offen lds
    s_add_u32 m0, s36, 8192
    s_add_u32 s39, s35, 1376256
    buffer_load_dwordx4 v8, s[24:27], s39 offen lds
    s_add_u32 m0, s36, 16384
    s_nop 0
    buffer_load_dwordx4 v8, s[28:31], s39 offen lds
    s_add_u32 m0, s36, 1024
    s_add_u32 s38, s34, 99328
    buffer_load_dwordx4 v6, s[20:23], s38 offen lds
    s_add_u32 m0, s36, 9216
    s_add_u32 s39, s35, 1390592
    buffer_load_dwordx4 v8, s[24:27], s39 offen lds
    s_add_u32 m0, s36, 17408
    s_nop 0
    buffer_load_dwordx4 v8, s[28:31], s39 offen lds
    s_waitcnt vmcnt(18)
    s_barrier
    s_add_u32 m0, s36, 24576
    s_add_u32 s38, s34, 106496
    buffer_load_dwordx4 v6, s[20:23], s38 offen lds
    s_add_u32 m0, s36, 32768
    s_add_u32 s39, s35, 1490944
    buffer_load_dwordx4 v8, s[24:27], s39 offen lds
    s_add_u32 m0, s36, 40960
    s_nop 0
    buffer_load_dwordx4 v8, s[28:31], s39 offen lds
    s_add_u32 m0, s36, 25600
    s_add_u32 s38, s34, 107520
    buffer_load_dwordx4 v6, s[20:23], s38 offen lds
    s_add_u32 m0, s36, 33792
    s_add_u32 s39, s35, 1505280
    buffer_load_dwordx4 v8, s[24:27], s39 offen lds
    s_add_u32 m0, s36, 41984
    s_nop 0
    buffer_load_dwordx4 v8, s[28:31], s39 offen lds
    s_waitcnt vmcnt(18)
    s_barrier
    s_add_u32 m0, s36, 49152
    s_add_u32 s38, s34, 114688
    buffer_load_dwordx4 v6, s[20:23], s38 offen lds
    s_add_u32 m0, s36, 57344
    s_add_u32 s39, s35, 1605632
    buffer_load_dwordx4 v8, s[24:27], s39 offen lds
    s_add_u32 m0, s36, 65536
    s_nop 0
    buffer_load_dwordx4 v8, s[28:31], s39 offen lds
    s_add_u32 m0, s36, 50176
    s_add_u32 s38, s34, 115712
    buffer_load_dwordx4 v6, s[20:23], s38 offen lds
    s_add_u32 m0, s36, 58368
    s_add_u32 s39, s35, 1619968
    buffer_load_dwordx4 v8, s[24:27], s39 offen lds
    s_add_u32 m0, s36, 66560
    s_nop 0
    buffer_load_dwordx4 v8, s[28:31], s39 offen lds
    s_waitcnt vmcnt(18)
    s_barrier
    s_add_u32 m0, s36, 73728
    s_add_u32 s38, s34, 122880
    buffer_load_dwordx4 v6, s[20:23], s38 offen lds
    s_add_u32 m0, s36, 81920
    s_add_u32 s39, s35, 1720320
    buffer_load_dwordx4 v8, s[24:27], s39 offen lds
    s_add_u32 m0, s36, 90112
    s_nop 0
    buffer_load_dwordx4 v8, s[28:31], s39 offen lds
    s_add_u32 m0, s36, 74752
    s_add_u32 s38, s34, 123904
    buffer_load_dwordx4 v6, s[20:23], s38 offen lds
    s_add_u32 m0, s36, 82944
    s_add_u32 s39, s35, 1734656
    buffer_load_dwordx4 v8, s[24:27], s39 offen lds
    s_add_u32 m0, s36, 91136
    s_nop 0
    buffer_load_dwordx4 v8, s[28:31], s39 offen lds
    s_waitcnt vmcnt(18)
    s_barrier
    s_waitcnt vmcnt(12)
    s_barrier
    s_waitcnt vmcnt(6)
    s_barrier
    s_waitcnt vmcnt(0)
    s_barrier
    s_waitcnt vmcnt(0)
    s_barrier
    s_barrier
    s_barrier
    s_branch K3_STORE
K3_CONS:
    v_and_b32 v10, 31, v0
    v_lshrrev_b32 v11, 5, v0
    s_lshr_b32 s40, s18, 2
    s_lshl_b32 s40, s40, 6
    v_add_u32 v12, s40, v10
    v_lshlrev_b32 v12, 6, v12
    v_bfe_u32 v13, v10, 2, 2

    v_add_u32 v14, 0, v11
    v_xor_b32 v14, v14, v13
    v_lshl_add_u32 v16, v14, 4, v12
    v_add_u32 v18, 49152, v16
    v_add_u32 v20, 98304, v16
    v_add_u32 v14, 2, v11
    v_xor_b32 v14, v14, v13
    v_lshl_add_u32 v17, v14, 4, v12
    v_add_u32 v19, 49152, v17
    v_add_u32 v21, 98304, v17
    v_lshrrev_b32 v14, 2, v3
    v_lshl_add_u32 v15, v11, 3, v14
    v_and_b32 v10, 1, v2
    v_lshlrev_b32 v10, 5, v10
    v_and_b32 v12, 3, v3
    v_lshl_add_u32 v10, v12, 3, v10
    s_and_b32 s40, s18, 3
    s_lshl_b32 s40, s40, 6
    v_add_u32 v10, s40, v10
    v_lshlrev_b32 v14, 6, v14
    v_xor_b32 v10, v10, v14
    v_lshl_add_u32 v10, v15, 8, v10
    v_add_u32 v22, 8192, v10
    v_add_u32 v23, 57344, v10
    v_add_u32 v24, 106496, v10

    s_barrier
    ds_read_b64_tr_b16 v[32:33], v22 offset:0
    ds_read_b64_tr_b16 v[34:35], v22 offset:1024
    ds_read_b128 v[40:43], v16 offset:0
    ds_read_b64_tr_b16 v[36:37], v22 offset:8192
    ds_read_b64_tr_b16 v[38:39], v22 offset:9216
    ds_read_b128 v[44:47], v16 offset:2048
    ds_read_b64_tr_b16 v[48:49], v22 offset:4096
    ds_read_b64_tr_b16 v[50:51], v22 offset:5120
    ds_read_b128 v[56:59], v17 offset:0
    ds_read_b64_tr_b16 v[52:53], v22 offset:12288
    ds_read_b64_tr_b16 v[54:55], v22 offset:13312
    ds_read_b128 v[60:63], v17 offset:2048
    s_waitcnt lgkmcnt(6)
    v_mfma_f32_32x32x16_bf16 v[64:79], v[32:35], v[40:43], 0
    v_mfma_f32_32x32x16_bf16 v[96:111], v[36:39], v[40:43], 0
    v_mfma_f32_32x32x16_bf16 v[80:95], v[32:35], v[44:47], 0
    v_mfma_f32_32x32x16_bf16 v[112:127], v[36:39], v[44:47], 0
    ds_read_b64_tr_b16 v[32:33], v22 offset:24576
    ds_read_b64_tr_b16 v[34:35], v22 offset:25600
    ds_read_b128 v[40:43], v16 offset:24576
    ds_read_b64_tr_b16 v[36:37], v22 offset:32768
    ds_read_b64_tr_b16 v[38:39], v22 offset:33792
    ds_read_b128 v[44:47], v16 offset:26624
    s_waitcnt lgkmcnt(6)
    v_mfma_f32_32x32x16_bf16 v[64:79], v[48:51], v[56:59], v[64:79]
    v_mfma_f32_32x32x16_bf16 v[96:111], v[52:55], v[56:59], v[96:111]
    v_mfma_f32_32x32x16_bf16 v[80:95], v[48:51], v[60:63], v[80:95]
    v_mfma_f32_32x32x16_bf16 v[112:127], v[52:55], v[60:63], v[112:127]
    s_barrier
    ds_read_b64_tr_b16 v[48:49], v22 offset:28672
    ds_read_b64_tr_b16 v[50:51], v22 offset:29696
    ds_read_b128 v[56:59], v17 offset:24576
    ds_read_b64_tr_b16 v[52:53], v22 offset:36864
    ds_read_b64_tr_b16 v[54:55], v22 offset:37888
    ds_read_b128 v[60:63], v17 offset:26624
    s_waitcnt lgkmcnt(6)
    v_mfma_f32_32x32x16_bf16 v[64:79], v[32:35], v[40:43], v[64:79]
    v_mfma_f32_32x32x16_bf16 v[96:111], v[36:39], v[40:43], v[96:111]
    v_mfma_f32_32x32x16_bf16 v[80:95], v[32:35], v[44:47], v[80:95]
    v_mfma_f32_32x32x16_bf16 v[112:127], v[36:39], v[44:47], v[112:127]
    ds_read_b64_tr_b16 v[32:33], v23 offset:0
    ds_read_b64_tr_b16 v[34:35], v23 offset:1024
    ds_read_b128 v[40:43], v18 offset:0
    ds_read_b64_tr_b16 v[36:37], v23 offset:8192
    ds_read_b64_tr_b16 v[38:39], v23 offset:9216
    ds_read_b128 v[44:47], v18 offset:2048
    s_waitcnt lgkmcnt(6)
    v_mfma_f32_32x32x16_bf16 v[64:79], v[48:51], v[56:59], v[64:79]
    v_mfma_f32_32x32x16_bf16 v[96:111], v[52:55], v[56:59], v[96:111]
    v_mfma_f32_32x32x16_bf16 v[80:95], v[48:51], v[60:63], v[80:95]
    v_mfma_f32_32x32x16_bf16 v[112:127], v[52:55], v[60:63], v[112:127]
    s_barrier
    ds_read_b64_tr_b16 v[48:49], v23 offset:4096
    ds_read_b64_tr_b16 v[50:51], v23 offset:5120
    ds_read_b128 v[56:59], v19 offset:0
    ds_read_b64_tr_b16 v[52:53], v23 offset:12288
    ds_read_b64_tr_b16 v[54:55], v23 offset:13312
    ds_read_b128 v[60:63], v19 offset:2048
    s_waitcnt lgkmcnt(6)
    v_mfma_f32_32x32x16_bf16 v[64:79], v[32:35], v[40:43], v[64:79]
    v_mfma_f32_32x32x16_bf16 v[96:111], v[36:39], v[40:43], v[96:111]
    v_mfma_f32_32x32x16_bf16 v[80:95], v[32:35], v[44:47], v[80:95]
    v_mfma_f32_32x32x16_bf16 v[112:127], v[36:39], v[44:47], v[112:127]
    ds_read_b64_tr_b16 v[32:33], v23 offset:24576
    ds_read_b64_tr_b16 v[34:35], v23 offset:25600
    ds_read_b128 v[40:43], v18 offset:24576
    ds_read_b64_tr_b16 v[36:37], v23 offset:32768
    ds_read_b64_tr_b16 v[38:39], v23 offset:33792
    ds_read_b128 v[44:47], v18 offset:26624
    s_waitcnt lgkmcnt(6)
    v_mfma_f32_32x32x16_bf16 v[64:79], v[48:51], v[56:59], v[64:79]
    v_mfma_f32_32x32x16_bf16 v[96:111], v[52:55], v[56:59], v[96:111]
    v_mfma_f32_32x32x16_bf16 v[80:95], v[48:51], v[60:63], v[80:95]
    v_mfma_f32_32x32x16_bf16 v[112:127], v[52:55], v[60:63], v[112:127]
    s_barrier
    ds_read_b64_tr_b16 v[48:49], v23 offset:28672
    ds_read_b64_tr_b16 v[50:51], v23 offset:29696
    ds_read_b128 v[56:59], v19 offset:24576
    ds_read_b64_tr_b16 v[52:53], v23 offset:36864
    ds_read_b64_tr_b16 v[54:55], v23 offset:37888
    ds_read_b128 v[60:63], v19 offset:26624
    s_waitcnt lgkmcnt(6)
    v_mfma_f32_32x32x16_bf16 v[64:79], v[32:35], v[40:43], v[64:79]
    v_mfma_f32_32x32x16_bf16 v[96:111], v[36:39], v[40:43], v[96:111]
    v_mfma_f32_32x32x16_bf16 v[80:95], v[32:35], v[44:47], v[80:95]
    v_mfma_f32_32x32x16_bf16 v[112:127], v[36:39], v[44:47], v[112:127]
    ds_read_b64_tr_b16 v[32:33], v24 offset:0
    ds_read_b64_tr_b16 v[34:35], v24 offset:1024
    ds_read_b128 v[40:43], v20 offset:0
    ds_read_b64_tr_b16 v[36:37], v24 offset:8192
    ds_read_b64_tr_b16 v[38:39], v24 offset:9216
    ds_read_b128 v[44:47], v20 offset:2048
    s_waitcnt lgkmcnt(6)
    v_mfma_f32_32x32x16_bf16 v[64:79], v[48:51], v[56:59], v[64:79]
    v_mfma_f32_32x32x16_bf16 v[96:111], v[52:55], v[56:59], v[96:111]
    v_mfma_f32_32x32x16_bf16 v[80:95], v[48:51], v[60:63], v[80:95]
    v_mfma_f32_32x32x16_bf16 v[112:127], v[52:55], v[60:63], v[112:127]
    s_barrier
    ds_read_b64_tr_b16 v[48:49], v24 offset:4096
    ds_read_b64_tr_b16 v[50:51], v24 offset:5120
    ds_read_b128 v[56:59], v21 offset:0
    ds_read_b64_tr_b16 v[52:53], v24 offset:12288
    ds_read_b64_tr_b16 v[54:55], v24 offset:13312
    ds_read_b128 v[60:63], v21 offset:2048
    s_waitcnt lgkmcnt(6)
    v_mfma_f32_32x32x16_bf16 v[64:79], v[32:35], v[40:43], v[64:79]
    v_mfma_f32_32x32x16_bf16 v[96:111], v[36:39], v[40:43], v[96:111]
    v_mfma_f32_32x32x16_bf16 v[80:95], v[32:35], v[44:47], v[80:95]
    v_mfma_f32_32x32x16_bf16 v[112:127], v[36:39], v[44:47], v[112:127]
    ds_read_b64_tr_b16 v[32:33], v24 offset:24576
    ds_read_b64_tr_b16 v[34:35], v24 offset:25600
    ds_read_b128 v[40:43], v20 offset:24576
    ds_read_b64_tr_b16 v[36:37], v24 offset:32768
    ds_read_b64_tr_b16 v[38:39], v24 offset:33792
    ds_read_b128 v[44:47], v20 offset:26624
    s_waitcnt lgkmcnt(6)
    v_mfma_f32_32x32x16_bf16 v[64:79], v[48:51], v[56:59], v[64:79]
    v_mfma_f32_32x32x16_bf16 v[96:111], v[52:55], v[56:59], v[96:111]
    v_mfma_f32_32x32x16_bf16 v[80:95], v[48:51], v[60:63], v[80:95]
    v_mfma_f32_32x32x16_bf16 v[112:127], v[52:55], v[60:63], v[112:127]
    s_barrier
    ds_read_b64_tr_b16 v[48:49], v24 offset:28672
    ds_read_b64_tr_b16 v[50:51], v24 offset:29696
    ds_read_b128 v[56:59], v21 offset:24576
    ds_read_b64_tr_b16 v[52:53], v24 offset:36864
    ds_read_b64_tr_b16 v[54:55], v24 offset:37888
    ds_read_b128 v[60:63], v21 offset:26624
    s_waitcnt lgkmcnt(6)
    v_mfma_f32_32x32x16_bf16 v[64:79], v[32:35], v[40:43], v[64:79]
    v_mfma_f32_32x32x16_bf16 v[96:111], v[36:39], v[40:43], v[96:111]
    v_mfma_f32_32x32x16_bf16 v[80:95], v[32:35], v[44:47], v[80:95]
    v_mfma_f32_32x32x16_bf16 v[112:127], v[36:39], v[44:47], v[112:127]
    ds_read_b64_tr_b16 v[32:33], v22 offset:0
    ds_read_b64_tr_b16 v[34:35], v22 offset:1024
    ds_read_b128 v[40:43], v16 offset:0
    ds_read_b64_tr_b16 v[36:37], v22 offset:8192
    ds_read_b64_tr_b16 v[38:39], v22 offset:9216
    ds_read_b128 v[44:47], v16 offset:2048
    s_waitcnt lgkmcnt(6)
    v_mfma_f32_32x32x16_bf16 v[64:79], v[48:51], v[56:59], v[64:79]
    v_mfma_f32_32x32x16_bf16 v[96:111], v[52:55], v[56:59], v[96:111]
    v_mfma_f32_32x32x16_bf16 v[80:95], v[48:51], v[60:63], v[80:95]
    v_mfma_f32_32x32x16_bf16 v[112:127], v[52:55], v[60:63], v[112:127]
    s_barrier
    ds_read_b64_tr_b16 v[48:49], v22 offset:4096
    ds_read_b64_tr_b16 v[50:51], v22 offset:5120
    ds_read_b128 v[56:59], v17 offset:0
    ds_read_b64_tr_b16 v[52:53], v22 offset:12288
    ds_read_b64_tr_b16 v[54:55], v22 offset:13312
    ds_read_b128 v[60:63], v17 offset:2048
    s_waitcnt lgkmcnt(6)
    v_mfma_f32_32x32x16_bf16 v[64:79], v[32:35], v[40:43], v[64:79]
    v_mfma_f32_32x32x16_bf16 v[96:111], v[36:39], v[40:43], v[96:111]
    v_mfma_f32_32x32x16_bf16 v[80:95], v[32:35], v[44:47], v[80:95]
    v_mfma_f32_32x32x16_bf16 v[112:127], v[36:39], v[44:47], v[112:127]
    ds_read_b64_tr_b16 v[32:33], v22 offset:24576
    ds_read_b64_tr_b16 v[34:35], v22 offset:25600
    ds_read_b128 v[40:43], v16 offset:24576
    ds_read_b64_tr_b16 v[36:37], v22 offset:32768
    ds_read_b64_tr_b16 v[38:39], v22 offset:33792
    ds_read_b128 v[44:47], v16 offset:26624
    s_waitcnt lgkmcnt(6)
    v_mfma_f32_32x32x16_bf16 v[64:79], v[48:51], v[56:59], v[64:79]
    v_mfma_f32_32x32x16_bf16 v[96:111], v[52:55], v[56:59], v[96:111]
    v_mfma_f32_32x32x16_bf16 v[80:95], v[48:51], v[60:63], v[80:95]
    v_mfma_f32_32x32x16_bf16 v[112:127], v[52:55], v[60:63], v[112:127]
    s_barrier
    ds_read_b64_tr_b16 v[48:49], v22 offset:28672
    ds_read_b64_tr_b16 v[50:51], v22 offset:29696
    ds_read_b128 v[56:59], v17 offset:24576
    ds_read_b64_tr_b16 v[52:53], v22 offset:36864
    ds_read_b64_tr_b16 v[54:55], v22 offset:37888
    ds_read_b128 v[60:63], v17 offset:26624
    s_waitcnt lgkmcnt(6)
    v_mfma_f32_32x32x16_bf16 v[64:79], v[32:35], v[40:43], v[64:79]
    v_mfma_f32_32x32x16_bf16 v[96:111], v[36:39], v[40:43], v[96:111]
    v_mfma_f32_32x32x16_bf16 v[80:95], v[32:35], v[44:47], v[80:95]
    v_mfma_f32_32x32x16_bf16 v[112:127], v[36:39], v[44:47], v[112:127]
    ds_read_b64_tr_b16 v[32:33], v23 offset:0
    ds_read_b64_tr_b16 v[34:35], v23 offset:1024
    ds_read_b128 v[40:43], v18 offset:0
    ds_read_b64_tr_b16 v[36:37], v23 offset:8192
    ds_read_b64_tr_b16 v[38:39], v23 offset:9216
    ds_read_b128 v[44:47], v18 offset:2048
    s_waitcnt lgkmcnt(6)
    v_mfma_f32_32x32x16_bf16 v[64:79], v[48:51], v[56:59], v[64:79]
    v_mfma_f32_32x32x16_bf16 v[96:111], v[52:55], v[56:59], v[96:111]
    v_mfma_f32_32x32x16_bf16 v[80:95], v[48:51], v[60:63], v[80:95]
    v_mfma_f32_32x32x16_bf16 v[112:127], v[52:55], v[60:63], v[112:127]
    s_barrier
    ds_read_b64_tr_b16 v[48:49], v23 offset:4096
    ds_read_b64_tr_b16 v[50:51], v23 offset:5120
    ds_read_b128 v[56:59], v19 offset:0
    ds_read_b64_tr_b16 v[52:53], v23 offset:12288
    ds_read_b64_tr_b16 v[54:55], v23 offset:13312
    ds_read_b128 v[60:63], v19 offset:2048
    s_waitcnt lgkmcnt(6)
    v_mfma_f32_32x32x16_bf16 v[64:79], v[32:35], v[40:43], v[64:79]
    v_mfma_f32_32x32x16_bf16 v[96:111], v[36:39], v[40:43], v[96:111]
    v_mfma_f32_32x32x16_bf16 v[80:95], v[32:35], v[44:47], v[80:95]
    v_mfma_f32_32x32x16_bf16 v[112:127], v[36:39], v[44:47], v[112:127]
    ds_read_b64_tr_b16 v[32:33], v23 offset:24576
    ds_read_b64_tr_b16 v[34:35], v23 offset:25600
    ds_read_b128 v[40:43], v18 offset:24576
    ds_read_b64_tr_b16 v[36:37], v23 offset:32768
    ds_read_b64_tr_b16 v[38:39], v23 offset:33792
    ds_read_b128 v[44:47], v18 offset:26624
    s_waitcnt lgkmcnt(6)
    v_mfma_f32_32x32x16_bf16 v[64:79], v[48:51], v[56:59], v[64:79]
    v_mfma_f32_32x32x16_bf16 v[96:111], v[52:55], v[56:59], v[96:111]
    v_mfma_f32_32x32x16_bf16 v[80:95], v[48:51], v[60:63], v[80:95]
    v_mfma_f32_32x32x16_bf16 v[112:127], v[52:55], v[60:63], v[112:127]
    s_barrier
    ds_read_b64_tr_b16 v[48:49], v23 offset:28672
    ds_read_b64_tr_b16 v[50:51], v23 offset:29696
    ds_read_b128 v[56:59], v19 offset:24576
    ds_read_b64_tr_b16 v[52:53], v23 offset:36864
    ds_read_b64_tr_b16 v[54:55], v23 offset:37888
    ds_read_b128 v[60:63], v19 offset:26624
    s_waitcnt lgkmcnt(6)
    v_mfma_f32_32x32x16_bf16 v[64:79], v[32:35], v[40:43], v[64:79]
    v_mfma_f32_32x32x16_bf16 v[96:111], v[36:39], v[40:43], v[96:111]
    v_mfma_f32_32x32x16_bf16 v[80:95], v[32:35], v[44:47], v[80:95]
    v_mfma_f32_32x32x16_bf16 v[112:127], v[36:39], v[44:47], v[112:127]
    ds_read_b64_tr_b16 v[32:33], v24 offset:0
    ds_read_b64_tr_b16 v[34:35], v24 offset:1024
    ds_read_b128 v[40:43], v20 offset:0
    ds_read_b64_tr_b16 v[36:37], v24 offset:8192
    ds_read_b64_tr_b16 v[38:39], v24 offset:9216
    ds_read_b128 v[44:47], v20 offset:2048
    s_waitcnt lgkmcnt(6)
    v_mfma_f32_32x32x16_bf16 v[64:79], v[48:51], v[56:59], v[64:79]
    v_mfma_f32_32x32x16_bf16 v[96:111], v[52:55], v[56:59], v[96:111]
    v_mfma_f32_32x32x16_bf16 v[80:95], v[48:51], v[60:63], v[80:95]
    v_mfma_f32_32x32x16_bf16 v[112:127], v[52:55], v[60:63], v[112:127]
    s_barrier
    ds_read_b64_tr_b16 v[48:49], v24 offset:4096
    ds_read_b64_tr_b16 v[50:51], v24 offset:5120
    ds_read_b128 v[56:59], v21 offset:0
    ds_read_b64_tr_b16 v[52:53], v24 offset:12288
    ds_read_b64_tr_b16 v[54:55], v24 offset:13312
    ds_read_b128 v[60:63], v21 offset:2048
    s_waitcnt lgkmcnt(6)
    v_mfma_f32_32x32x16_bf16 v[64:79], v[32:35], v[40:43], v[64:79]
    v_mfma_f32_32x32x16_bf16 v[96:111], v[36:39], v[40:43], v[96:111]
    v_mfma_f32_32x32x16_bf16 v[80:95], v[32:35], v[44:47], v[80:95]
    v_mfma_f32_32x32x16_bf16 v[112:127], v[36:39], v[44:47], v[112:127]
    ds_read_b64_tr_b16 v[32:33], v24 offset:24576
    ds_read_b64_tr_b16 v[34:35], v24 offset:25600
    ds_read_b128 v[40:43], v20 offset:24576
    ds_read_b64_tr_b16 v[36:37], v24 offset:32768
    ds_read_b64_tr_b16 v[38:39], v24 offset:33792
    ds_read_b128 v[44:47], v20 offset:26624
    s_waitcnt lgkmcnt(6)
    v_mfma_f32_32x32x16_bf16 v[64:79], v[48:51], v[56:59], v[64:79]
    v_mfma_f32_32x32x16_bf16 v[96:111], v[52:55], v[56:59], v[96:111]
    v_mfma_f32_32x32x16_bf16 v[80:95], v[48:51], v[60:63], v[80:95]
    v_mfma_f32_32x32x16_bf16 v[112:127], v[52:55], v[60:63], v[112:127]
    s_barrier
    ds_read_b64_tr_b16 v[48:49], v24 offset:28672
    ds_read_b64_tr_b16 v[50:51], v24 offset:29696
    ds_read_b128 v[56:59], v21 offset:24576
    ds_read_b64_tr_b16 v[52:53], v24 offset:36864
    ds_read_b64_tr_b16 v[54:55], v24 offset:37888
    ds_read_b128 v[60:63], v21 offset:26624
    s_waitcnt lgkmcnt(6)
    v_mfma_f32_32x32x16_bf16 v[64:79], v[32:35], v[40:43], v[64:79]
    v_mfma_f32_32x32x16_bf16 v[96:111], v[36:39], v[40:43], v[96:111]
    v_mfma_f32_32x32x16_bf16 v[80:95], v[32:35], v[44:47], v[80:95]
    v_mfma_f32_32x32x16_bf16 v[112:127], v[36:39], v[44:47], v[112:127]
    ds_read_b64_tr_b16 v[32:33], v22 offset:0
    ds_read_b64_tr_b16 v[34:35], v22 offset:1024
    ds_read_b128 v[40:43], v16 offset:0
    ds_read_b64_tr_b16 v[36:37], v22 offset:8192
    ds_read_b64_tr_b16 v[38:39], v22 offset:9216
    ds_read_b128 v[44:47], v16 offset:2048
    s_waitcnt lgkmcnt(6)
    v_mfma_f32_32x32x16_bf16 v[64:79], v[48:51], v[56:59], v[64:79]
    v_mfma_f32_32x32x16_bf16 v[96:111], v[52:55], v[56:59], v[96:111]
    v_mfma_f32_32x32x16_bf16 v[80:95], v[48:51], v[60:63], v[80:95]
    v_mfma_f32_32x32x16_bf16 v[112:127], v[52:55], v[60:63], v[112:127]
    s_barrier
    ds_read_b64_tr_b16 v[48:49], v22 offset:4096
    ds_read_b64_tr_b16 v[50:51], v22 offset:5120
    ds_read_b128 v[56:59], v17 offset:0
    ds_read_b64_tr_b16 v[52:53], v22 offset:12288
    ds_read_b64_tr_b16 v[54:55], v22 offset:13312
    ds_read_b128 v[60:63], v17 offset:2048
    s_waitcnt lgkmcnt(6)
    v_mfma_f32_32x32x16_bf16 v[64:79], v[32:35], v[40:43], v[64:79]
    v_mfma_f32_32x32x16_bf16 v[96:111], v[36:39], v[40:43], v[96:111]
    v_mfma_f32_32x32x16_bf16 v[80:95], v[32:35], v[44:47], v[80:95]
    v_mfma_f32_32x32x16_bf16 v[112:127], v[36:39], v[44:47], v[112:127]
    ds_read_b64_tr_b16 v[32:33], v22 offset:24576
    ds_read_b64_tr_b16 v[34:35], v22 offset:25600
    ds_read_b128 v[40:43], v16 offset:24576
    ds_read_b64_tr_b16 v[36:37], v22 offset:32768
    ds_read_b64_tr_b16 v[38:39], v22 offset:33792
    ds_read_b128 v[44:47], v16 offset:26624
    s_waitcnt lgkmcnt(6)
    v_mfma_f32_32x32x16_bf16 v[64:79], v[48:51], v[56:59], v[64:79]
    v_mfma_f32_32x32x16_bf16 v[96:111], v[52:55], v[56:59], v[96:111]
    v_mfma_f32_32x32x16_bf16 v[80:95], v[48:51], v[60:63], v[80:95]
    v_mfma_f32_32x32x16_bf16 v[112:127], v[52:55], v[60:63], v[112:127]
    s_barrier
    ds_read_b64_tr_b16 v[48:49], v22 offset:28672
    ds_read_b64_tr_b16 v[50:51], v22 offset:29696
    ds_read_b128 v[56:59], v17 offset:24576
    ds_read_b64_tr_b16 v[52:53], v22 offset:36864
    ds_read_b64_tr_b16 v[54:55], v22 offset:37888
    ds_read_b128 v[60:63], v17 offset:26624
    s_waitcnt lgkmcnt(6)
    v_mfma_f32_32x32x16_bf16 v[64:79], v[32:35], v[40:43], v[64:79]
    v_mfma_f32_32x32x16_bf16 v[96:111], v[36:39], v[40:43], v[96:111]
    v_mfma_f32_32x32x16_bf16 v[80:95], v[32:35], v[44:47], v[80:95]
    v_mfma_f32_32x32x16_bf16 v[112:127], v[36:39], v[44:47], v[112:127]
    ds_read_b64_tr_b16 v[32:33], v23 offset:0
    ds_read_b64_tr_b16 v[34:35], v23 offset:1024
    ds_read_b128 v[40:43], v18 offset:0
    ds_read_b64_tr_b16 v[36:37], v23 offset:8192
    ds_read_b64_tr_b16 v[38:39], v23 offset:9216
    ds_read_b128 v[44:47], v18 offset:2048
    s_waitcnt lgkmcnt(6)
    v_mfma_f32_32x32x16_bf16 v[64:79], v[48:51], v[56:59], v[64:79]
    v_mfma_f32_32x32x16_bf16 v[96:111], v[52:55], v[56:59], v[96:111]
    v_mfma_f32_32x32x16_bf16 v[80:95], v[48:51], v[60:63], v[80:95]
    v_mfma_f32_32x32x16_bf16 v[112:127], v[52:55], v[60:63], v[112:127]
    s_barrier
    ds_read_b64_tr_b16 v[48:49], v23 offset:4096
    ds_read_b64_tr_b16 v[50:51], v23 offset:5120
    ds_read_b128 v[56:59], v19 offset:0
    ds_read_b64_tr_b16 v[52:53], v23 offset:12288
    ds_read_b64_tr_b16 v[54:55], v23 offset:13312
    ds_read_b128 v[60:63], v19 offset:2048
    s_waitcnt lgkmcnt(6)
    v_mfma_f32_32x32x16_bf16 v[64:79], v[32:35], v[40:43], v[64:79]
    v_mfma_f32_32x32x16_bf16 v[96:111], v[36:39], v[40:43], v[96:111]
    v_mfma_f32_32x32x16_bf16 v[80:95], v[32:35], v[44:47], v[80:95]
    v_mfma_f32_32x32x16_bf16 v[112:127], v[36:39], v[44:47], v[112:127]
    ds_read_b64_tr_b16 v[32:33], v23 offset:24576
    ds_read_b64_tr_b16 v[34:35], v23 offset:25600
    ds_read_b128 v[40:43], v18 offset:24576
    ds_read_b64_tr_b16 v[36:37], v23 offset:32768
    ds_read_b64_tr_b16 v[38:39], v23 offset:33792
    ds_read_b128 v[44:47], v18 offset:26624
    s_waitcnt lgkmcnt(6)
    v_mfma_f32_32x32x16_bf16 v[64:79], v[48:51], v[56:59], v[64:79]
    v_mfma_f32_32x32x16_bf16 v[96:111], v[52:55], v[56:59], v[96:111]
    v_mfma_f32_32x32x16_bf16 v[80:95], v[48:51], v[60:63], v[80:95]
    v_mfma_f32_32x32x16_bf16 v[112:127], v[52:55], v[60:63], v[112:127]
    s_barrier
    ds_read_b64_tr_b16 v[48:49], v23 offset:28672
    ds_read_b64_tr_b16 v[50:51], v23 offset:29696
    ds_read_b128 v[56:59], v19 offset:24576
    ds_read_b64_tr_b16 v[52:53], v23 offset:36864
    ds_read_b64_tr_b16 v[54:55], v23 offset:37888
    ds_read_b128 v[60:63], v19 offset:26624
    s_waitcnt lgkmcnt(6)
    v_mfma_f32_32x32x16_bf16 v[64:79], v[32:35], v[40:43], v[64:79]
    v_mfma_f32_32x32x16_bf16 v[96:111], v[36:39], v[40:43], v[96:111]
    v_mfma_f32_32x32x16_bf16 v[80:95], v[32:35], v[44:47], v[80:95]
    v_mfma_f32_32x32x16_bf16 v[112:127], v[36:39], v[44:47], v[112:127]
    s_waitcnt lgkmcnt(0)
    v_mfma_f32_32x32x16_bf16 v[64:79], v[48:51], v[56:59], v[64:79]
    v_mfma_f32_32x32x16_bf16 v[96:111], v[52:55], v[56:59], v[96:111]
    v_mfma_f32_32x32x16_bf16 v[80:95], v[48:51], v[60:63], v[80:95]
    v_mfma_f32_32x32x16_bf16 v[112:127], v[52:55], v[60:63], v[112:127]
    v_and_b32 v10, 31, v0
    s_lshr_b32 s41, s18, 2
    s_lshl_b32 s41, s41, 6
    v_add_u32 v10, s41, v10
    s_movk_i32 s42, 272
    v_mul_lo_u32 v10, v10, s42
    v_lshl_add_u32 v10, v11, 3, v10
    s_and_b32 s41, s18, 3
    s_lshl_b32 s41, s41, 6
    v_add_u32 v10, s41, v10
    v_mov_b32 v12, 3222493025
    v_mov_b32 v13, 3222493025
    v_mov_b32 v14, 3184710632
    v_mov_b32 v15, 3184710632
    v_mov_b32 v16, 1.0
    v_mov_b32 v17, 1.0
    s_barrier

    v_pk_mul_f32 v[32:33], v[64:65], v[64:65]
    v_pk_mul_f32 v[34:35], v[66:67], v[66:67]
    v_pk_mul_f32 v[36:37], v[68:69], v[68:69]
    v_pk_mul_f32 v[38:39], v[70:71], v[70:71]
    v_pk_mul_f32 v[40:41], v[72:73], v[72:73]
    v_pk_mul_f32 v[42:43], v[74:75], v[74:75]
    v_pk_mul_f32 v[44:45], v[76:77], v[76:77]
    v_pk_mul_f32 v[46:47], v[78:79], v[78:79]
    v_pk_fma_f32 v[32:33], v[32:33], v[14:15], v[12:13]
    v_pk_fma_f32 v[34:35], v[34:35], v[14:15], v[12:13]
    v_pk_fma_f32 v[36:37], v[36:37], v[14:15], v[12:13]
    v_pk_fma_f32 v[38:39], v[38:39], v[14:15], v[12:13]
    v_pk_fma_f32 v[40:41], v[40:41], v[14:15], v[12:13]
    v_pk_fma_f32 v[42:43], v[42:43], v[14:15], v[12:13]
    v_pk_fma_f32 v[44:45], v[44:45], v[14:15], v[12:13]
    v_pk_fma_f32 v[46:47], v[46:47], v[14:15], v[12:13]
    v_pk_mul_f32 v[32:33], v[32:33], v[64:65]
    v_pk_mul_f32 v[34:35], v[34:35], v[66:67]
    v_pk_mul_f32 v[36:37], v[36:37], v[68:69]
    v_pk_mul_f32 v[38:39], v[38:39], v[70:71]
    v_pk_mul_f32 v[40:41], v[40:41], v[72:73]
    v_pk_mul_f32 v[42:43], v[42:43], v[74:75]
    v_pk_mul_f32 v[44:45], v[44:45], v[76:77]
    v_pk_mul_f32 v[46:47], v[46:47], v[78:79]
    v_exp_f32 v32, v32
    v_exp_f32 v33, v33
    v_exp_f32 v34, v34
    v_exp_f32 v35, v35
    v_exp_f32 v36, v36
    v_exp_f32 v37, v37
    v_exp_f32 v38, v38
    v_exp_f32 v39, v39
    v_exp_f32 v40, v40
    v_exp_f32 v41, v41
    v_exp_f32 v42, v42
    v_exp_f32 v43, v43
    v_exp_f32 v44, v44
    v_exp_f32 v45, v45
    v_exp_f32 v46, v46
    v_exp_f32 v47, v47
    v_pk_mul_f32 v[64:65], v[64:65], v[96:97]
    v_pk_mul_f32 v[66:67], v[66:67], v[98:99]
    v_pk_mul_f32 v[68:69], v[68:69], v[100:101]
    v_pk_mul_f32 v[70:71], v[70:71], v[102:103]
    v_pk_mul_f32 v[72:73], v[72:73], v[104:105]
    v_pk_mul_f32 v[74:75], v[74:75], v[106:107]
    v_pk_mul_f32 v[76:77], v[76:77], v[108:109]
    v_pk_mul_f32 v[78:79], v[78:79], v[110:111]
    v_pk_add_f32 v[32:33], v[32:33], v[16:17]
    v_pk_add_f32 v[34:35], v[34:35], v[16:17]
    v_pk_add_f32 v[36:37], v[36:37], v[16:17]
    v_pk_add_f32 v[38:39], v[38:39], v[16:17]
    v_pk_add_f32 v[40:41], v[40:41], v[16:17]
    v_pk_add_f32 v[42:43], v[42:43], v[16:17]
    v_pk_add_f32 v[44:45], v[44:45], v[16:17]
    v_pk_add_f32 v[46:47], v[46:47], v[16:17]
    v_rcp_f32 v32, v32
    v_rcp_f32 v33, v33
    v_rcp_f32 v34, v34
    v_rcp_f32 v35, v35
    v_rcp_f32 v36, v36
    v_rcp_f32 v37, v37
    v_rcp_f32 v38, v38
    v_rcp_f32 v39, v39
    v_rcp_f32 v40, v40
    v_rcp_f32 v41, v41
    v_rcp_f32 v42, v42
    v_rcp_f32 v43, v43
    v_rcp_f32 v44, v44
    v_rcp_f32 v45, v45
    v_rcp_f32 v46, v46
    v_rcp_f32 v47, v47
    s_nop 0
    v_pk_mul_f32 v[32:33], v[32:33], v[64:65]
    v_pk_mul_f32 v[34:35], v[34:35], v[66:67]
    v_pk_mul_f32 v[36:37], v[36:37], v[68:69]
    v_pk_mul_f32 v[38:39], v[38:39], v[70:71]
    v_pk_mul_f32 v[40:41], v[40:41], v[72:73]
    v_pk_mul_f32 v[42:43], v[42:43], v[74:75]
    v_pk_mul_f32 v[44:45], v[44:45], v[76:77]
    v_pk_mul_f32 v[46:47], v[46:47], v[78:79]
    v_cvt_pk_bf16_f32 v48, v32, v33
    v_cvt_pk_bf16_f32 v49, v34, v35
    v_cvt_pk_bf16_f32 v50, v36, v37
    v_cvt_pk_bf16_f32 v51, v38, v39
    v_cvt_pk_bf16_f32 v52, v40, v41
    v_cvt_pk_bf16_f32 v53, v42, v43
    v_cvt_pk_bf16_f32 v54, v44, v45
    v_cvt_pk_bf16_f32 v55, v46, v47
    ds_write_b64 v10, v[48:49] offset:0
    ds_write_b64 v10, v[50:51] offset:16
    ds_write_b64 v10, v[52:53] offset:32
    ds_write_b64 v10, v[54:55] offset:48
    v_pk_mul_f32 v[32:33], v[80:81], v[80:81]
    v_pk_mul_f32 v[34:35], v[82:83], v[82:83]
    v_pk_mul_f32 v[36:37], v[84:85], v[84:85]
    v_pk_mul_f32 v[38:39], v[86:87], v[86:87]
    v_pk_mul_f32 v[40:41], v[88:89], v[88:89]
    v_pk_mul_f32 v[42:43], v[90:91], v[90:91]
    v_pk_mul_f32 v[44:45], v[92:93], v[92:93]
    v_pk_mul_f32 v[46:47], v[94:95], v[94:95]
    v_pk_fma_f32 v[32:33], v[32:33], v[14:15], v[12:13]
    v_pk_fma_f32 v[34:35], v[34:35], v[14:15], v[12:13]
    v_pk_fma_f32 v[36:37], v[36:37], v[14:15], v[12:13]
    v_pk_fma_f32 v[38:39], v[38:39], v[14:15], v[12:13]
    v_pk_fma_f32 v[40:41], v[40:41], v[14:15], v[12:13]
    v_pk_fma_f32 v[42:43], v[42:43], v[14:15], v[12:13]
    v_pk_fma_f32 v[44:45], v[44:45], v[14:15], v[12:13]
    v_pk_fma_f32 v[46:47], v[46:47], v[14:15], v[12:13]
    v_pk_mul_f32 v[32:33], v[32:33], v[80:81]
    v_pk_mul_f32 v[34:35], v[34:35], v[82:83]
    v_pk_mul_f32 v[36:37], v[36:37], v[84:85]
    v_pk_mul_f32 v[38:39], v[38:39], v[86:87]
    v_pk_mul_f32 v[40:41], v[40:41], v[88:89]
    v_pk_mul_f32 v[42:43], v[42:43], v[90:91]
    v_pk_mul_f32 v[44:45], v[44:45], v[92:93]
    v_pk_mul_f32 v[46:47], v[46:47], v[94:95]
    v_exp_f32 v32, v32
    v_exp_f32 v33, v33
    v_exp_f32 v34, v34
    v_exp_f32 v35, v35
    v_exp_f32 v36, v36
    v_exp_f32 v37, v37
    v_exp_f32 v38, v38
    v_exp_f32 v39, v39
    v_exp_f32 v40, v40
    v_exp_f32 v41, v41
    v_exp_f32 v42, v42
    v_exp_f32 v43, v43
    v_exp_f32 v44, v44
    v_exp_f32 v45, v45
    v_exp_f32 v46, v46
    v_exp_f32 v47, v47
    v_pk_mul_f32 v[80:81], v[80:81], v[112:113]
    v_pk_mul_f32 v[82:83], v[82:83], v[114:115]
    v_pk_mul_f32 v[84:85], v[84:85], v[116:117]
    v_pk_mul_f32 v[86:87], v[86:87], v[118:119]
    v_pk_mul_f32 v[88:89], v[88:89], v[120:121]
    v_pk_mul_f32 v[90:91], v[90:91], v[122:123]
    v_pk_mul_f32 v[92:93], v[92:93], v[124:125]
    v_pk_mul_f32 v[94:95], v[94:95], v[126:127]
    v_pk_add_f32 v[32:33], v[32:33], v[16:17]
    v_pk_add_f32 v[34:35], v[34:35], v[16:17]
    v_pk_add_f32 v[36:37], v[36:37], v[16:17]
    v_pk_add_f32 v[38:39], v[38:39], v[16:17]
    v_pk_add_f32 v[40:41], v[40:41], v[16:17]
    v_pk_add_f32 v[42:43], v[42:43], v[16:17]
    v_pk_add_f32 v[44:45], v[44:45], v[16:17]
    v_pk_add_f32 v[46:47], v[46:47], v[16:17]
    v_rcp_f32 v32, v32
    v_rcp_f32 v33, v33
    v_rcp_f32 v34, v34
    v_rcp_f32 v35, v35
    v_rcp_f32 v36, v36
    v_rcp_f32 v37, v37
    v_rcp_f32 v38, v38
    v_rcp_f32 v39, v39
    v_rcp_f32 v40, v40
    v_rcp_f32 v41, v41
    v_rcp_f32 v42, v42
    v_rcp_f32 v43, v43
    v_rcp_f32 v44, v44
    v_rcp_f32 v45, v45
    v_rcp_f32 v46, v46
    v_rcp_f32 v47, v47
    s_nop 0
    v_pk_mul_f32 v[32:33], v[32:33], v[80:81]
    v_pk_mul_f32 v[34:35], v[34:35], v[82:83]
    v_pk_mul_f32 v[36:37], v[36:37], v[84:85]
    v_pk_mul_f32 v[38:39], v[38:39], v[86:87]
    v_pk_mul_f32 v[40:41], v[40:41], v[88:89]
    v_pk_mul_f32 v[42:43], v[42:43], v[90:91]
    v_pk_mul_f32 v[44:45], v[44:45], v[92:93]
    v_pk_mul_f32 v[46:47], v[46:47], v[94:95]
    v_cvt_pk_bf16_f32 v48, v32, v33
    v_cvt_pk_bf16_f32 v49, v34, v35
    v_cvt_pk_bf16_f32 v50, v36, v37
    v_cvt_pk_bf16_f32 v51, v38, v39
    v_cvt_pk_bf16_f32 v52, v40, v41
    v_cvt_pk_bf16_f32 v53, v42, v43
    v_cvt_pk_bf16_f32 v54, v44, v45
    v_cvt_pk_bf16_f32 v55, v46, v47
    ds_write_b64 v10, v[48:49] offset:8704
    ds_write_b64 v10, v[50:51] offset:8720
    ds_write_b64 v10, v[52:53] offset:8736
    ds_write_b64 v10, v[54:55] offset:8752
    s_waitcnt lgkmcnt(0)
    s_barrier
K3_STORE:
    s_lshl_b32 s40, s18, 2
    v_add_u32 v10, s40, v2
    s_movk_i32 s42, 272
    v_mul_lo_u32 v12, v10, s42
    v_lshl_add_u32 v12, v3, 4, v12
    s_lshl_b32 s40, s16, 7
    v_add_u32 v10, s40, v10
    v_mul_lo_u32 v10, v10, s33
    v_lshl_add_u32 v10, v3, 4, v10
    s_lshl_b32 s40, s17, 8
    s_add_u32 s40, s40, 7340032
    v_add_u32 v10, s40, v10
    v_add_u32 v13, 172032, v10
    v_add_u32 v14, 344064, v10
    ds_read_b128 v[32:35], v12
    ds_read_b128 v[36:39], v12 offset:13056
    s_cmp_ge_u32 s18, 8
    s_cbranch_scc1 K3_ST2
    ds_read_b128 v[40:43], v12 offset:26112
    s_waitcnt lgkmcnt(0)
    global_store_dwordx4 v14, v[40:43], s[14:15] sc1
    K3_ST2:
    s_waitcnt lgkmcnt(0)
    global_store_dwordx4 v10, v[32:35], s[14:15] sc1
    global_store_dwordx4 v13, v[36:39], s[14:15] sc1

K3_END:
    s_endpgm
.globl k4_ffn_down_kernel
.p2align 8
.type k4_ffn_down_kernel,@function
k4_ffn_down_kernel:
    s_cmp_ge_u32 s2, 256
    s_cbranch_scc1 K4_END
    s_load_dwordx4 s[4:7], s[0:1], 64
    s_load_dwordx2 s[14:15], s[0:1], 88
    v_lshrrev_b32 v1, 6, v0
    v_and_b32 v0, 63, v0
    s_and_b32 s16, s2, 7
    s_lshl_b32 s16, s16, 2
    s_lshr_b32 s17, s2, 6
    s_add_u32 s16, s16, s17
    s_lshr_b32 s17, s2, 3
    s_and_b32 s17, s17, 7
    v_readfirstlane_b32 s18, v1
    v_lshrrev_b32 v2, 4, v0
    v_and_b32 v3, 15, v0
    s_waitcnt lgkmcnt(0)

    s_cmp_lt_u32 s18, 4
    s_cbranch_scc1 K4_CONS
    s_add_u32 s20, s14, 7340032
    s_addc_u32 s21, s15, 0
    s_mov_b32 s22, 7340032
    s_mov_b32 s23, 0x00020000
    s_add_u32 s24, s14, 15728640
    s_addc_u32 s25, s15, 0
    s_mov_b32 s26, 1835008
    s_mov_b32 s27, 0x00020000
    s_sub_u32 s19, s18, 4
    s_movk_i32 s33, 3584
    v_mul_lo_u32 v4, v2, s33

    v_add_u32 v5, 0, v2
    v_xor_b32 v5, v3, v5
    v_lshl_add_u32 v6, v5, 4, v4
    v_add_u32 v5, 4, v2
    v_xor_b32 v5, v3, v5
    v_lshl_add_u32 v7, v5, 4, v4
    v_add_u32 v7, 14336, v7
    v_add_u32 v5, 8, v2
    v_xor_b32 v5, v3, v5
    v_lshl_add_u32 v8, v5, 4, v4
    v_add_u32 v8, 28672, v8
    v_add_u32 v5, 12, v2
    v_xor_b32 v5, v3, v5
    v_lshl_add_u32 v9, v5, 4, v4
    v_add_u32 v9, 43008, v9
    v_lshlrev_b32 v10, 4, v0
    s_mul_i32 s34, s16, 229376
    s_mul_i32 s35, s19, 57344
    s_add_u32 s34, s34, s35
    s_lshl_b32 s36, s19, 12
    s_mul_i32 s35, s17, 229376
    s_add_u32 s35, s35, s36

    s_add_u32 s38, s34, 0
    s_add_u32 m0, s36, 0
    s_add_u32 s40, s35, 0
    buffer_load_dwordx4 v6, s[20:23], s38 offen lds
    s_add_u32 m0, s36, 16384
    s_nop 0
    buffer_load_dwordx4 v10, s[24:27], s40 offen lds
    s_add_u32 m0, s36, 1024
    s_add_u32 s40, s35, 1024
    buffer_load_dwordx4 v7, s[20:23], s38 offen lds
    s_add_u32 m0, s36, 17408
    s_nop 0
    buffer_load_dwordx4 v10, s[24:27], s40 offen lds
    s_add_u32 m0, s36, 2048
    s_add_u32 s40, s35, 2048
    buffer_load_dwordx4 v8, s[20:23], s38 offen lds
    s_add_u32 m0, s36, 18432
    s_nop 0
    buffer_load_dwordx4 v10, s[24:27], s40 offen lds
    s_add_u32 m0, s36, 3072
    s_add_u32 s40, s35, 3072
    buffer_load_dwordx4 v9, s[20:23], s38 offen lds
    s_add_u32 m0, s36, 19456
    s_nop 0
    buffer_load_dwordx4 v10, s[24:27], s40 offen lds
    s_add_u32 s38, s34, 256
    s_add_u32 m0, s36, 32768
    s_add_u32 s40, s35, 16384
    buffer_load_dwordx4 v6, s[20:23], s38 offen lds
    s_add_u32 m0, s36, 49152
    s_nop 0
    buffer_load_dwordx4 v10, s[24:27], s40 offen lds
    s_add_u32 m0, s36, 33792
    s_add_u32 s40, s35, 17408
    buffer_load_dwordx4 v7, s[20:23], s38 offen lds
    s_add_u32 m0, s36, 50176
    s_nop 0
    buffer_load_dwordx4 v10, s[24:27], s40 offen lds
    s_add_u32 m0, s36, 34816
    s_add_u32 s40, s35, 18432
    buffer_load_dwordx4 v8, s[20:23], s38 offen lds
    s_add_u32 m0, s36, 51200
    s_nop 0
    buffer_load_dwordx4 v10, s[24:27], s40 offen lds
    s_add_u32 m0, s36, 35840
    s_add_u32 s40, s35, 19456
    buffer_load_dwordx4 v9, s[20:23], s38 offen lds
    s_add_u32 m0, s36, 52224
    s_nop 0
    buffer_load_dwordx4 v10, s[24:27], s40 offen lds
    s_add_u32 s38, s34, 512
    s_add_u32 m0, s36, 65536
    s_add_u32 s40, s35, 32768
    buffer_load_dwordx4 v6, s[20:23], s38 offen lds
    s_add_u32 m0, s36, 81920
    s_nop 0
    buffer_load_dwordx4 v10, s[24:27], s40 offen lds
    s_add_u32 m0, s36, 66560
    s_add_u32 s40, s35, 33792
    buffer_load_dwordx4 v7, s[20:23], s38 offen lds
    s_add_u32 m0, s36, 82944
    s_nop 0
    buffer_load_dwordx4 v10, s[24:27], s40 offen lds
    s_add_u32 m0, s36, 67584
    s_add_u32 s40, s35, 34816
    buffer_load_dwordx4 v8, s[20:23], s38 offen lds
    s_add_u32 m0, s36, 83968
    s_nop 0
    buffer_load_dwordx4 v10, s[24:27], s40 offen lds
    s_add_u32 m0, s36, 68608
    s_add_u32 s40, s35, 35840
    buffer_load_dwordx4 v9, s[20:23], s38 offen lds
    s_add_u32 m0, s36, 84992
    s_nop 0
    buffer_load_dwordx4 v10, s[24:27], s40 offen lds
    s_waitcnt vmcnt(16)
    s_barrier
    s_add_u32 s38, s34, 768
    s_add_u32 m0, s36, 98304
    s_add_u32 s40, s35, 49152
    buffer_load_dwordx4 v6, s[20:23], s38 offen lds
    s_add_u32 m0, s36, 114688
    s_nop 0
    buffer_load_dwordx4 v10, s[24:27], s40 offen lds
    s_add_u32 m0, s36, 99328
    s_add_u32 s40, s35, 50176
    buffer_load_dwordx4 v7, s[20:23], s38 offen lds
    s_add_u32 m0, s36, 115712
    s_nop 0
    buffer_load_dwordx4 v10, s[24:27], s40 offen lds
    s_add_u32 m0, s36, 100352
    s_add_u32 s40, s35, 51200
    buffer_load_dwordx4 v8, s[20:23], s38 offen lds
    s_add_u32 m0, s36, 116736
    s_nop 0
    buffer_load_dwordx4 v10, s[24:27], s40 offen lds
    s_add_u32 m0, s36, 101376
    s_add_u32 s40, s35, 52224
    buffer_load_dwordx4 v9, s[20:23], s38 offen lds
    s_add_u32 m0, s36, 117760
    s_nop 0
    buffer_load_dwordx4 v10, s[24:27], s40 offen lds
    s_waitcnt vmcnt(16)
    s_barrier
    s_add_u32 s38, s34, 1024
    s_add_u32 m0, s36, 0
    s_add_u32 s40, s35, 65536
    buffer_load_dwordx4 v6, s[20:23], s38 offen lds
    s_add_u32 m0, s36, 16384
    s_nop 0
    buffer_load_dwordx4 v10, s[24:27], s40 offen lds
    s_add_u32 m0, s36, 1024
    s_add_u32 s40, s35, 66560
    buffer_load_dwordx4 v7, s[20:23], s38 offen lds
    s_add_u32 m0, s36, 17408
    s_nop 0
    buffer_load_dwordx4 v10, s[24:27], s40 offen lds
    s_add_u32 m0, s36, 2048
    s_add_u32 s40, s35, 67584
    buffer_load_dwordx4 v8, s[20:23], s38 offen lds
    s_add_u32 m0, s36, 18432
    s_nop 0
    buffer_load_dwordx4 v10, s[24:27], s40 offen lds
    s_add_u32 m0, s36, 3072
    s_add_u32 s40, s35, 68608
    buffer_load_dwordx4 v9, s[20:23], s38 offen lds
    s_add_u32 m0, s36, 19456
    s_nop 0
    buffer_load_dwordx4 v10, s[24:27], s40 offen lds
    s_waitcnt vmcnt(16)
    s_barrier
    s_add_u32 s38, s34, 1280
    s_add_u32 m0, s36, 32768
    s_add_u32 s40, s35, 81920
    buffer_load_dwordx4 v6, s[20:23], s38 offen lds
    s_add_u32 m0, s36, 49152
    s_nop 0
    buffer_load_dwordx4 v10, s[24:27], s40 offen lds
    s_add_u32 m0, s36, 33792
    s_add_u32 s40, s35, 82944
    buffer_load_dwordx4 v7, s[20:23], s38 offen lds
    s_add_u32 m0, s36, 50176
    s_nop 0
    buffer_load_dwordx4 v10, s[24:27], s40 offen lds
    s_add_u32 m0, s36, 34816
    s_add_u32 s40, s35, 83968
    buffer_load_dwordx4 v8, s[20:23], s38 offen lds
    s_add_u32 m0, s36, 51200
    s_nop 0
    buffer_load_dwordx4 v10, s[24:27], s40 offen lds
    s_add_u32 m0, s36, 35840
    s_add_u32 s40, s35, 84992
    buffer_load_dwordx4 v9, s[20:23], s38 offen lds
    s_add_u32 m0, s36, 52224
    s_nop 0
    buffer_load_dwordx4 v10, s[24:27], s40 offen lds
    s_waitcnt vmcnt(16)
    s_barrier
    s_add_u32 s38, s34, 1536
    s_add_u32 m0, s36, 65536
    s_add_u32 s40, s35, 98304
    buffer_load_dwordx4 v6, s[20:23], s38 offen lds
    s_add_u32 m0, s36, 81920
    s_nop 0
    buffer_load_dwordx4 v10, s[24:27], s40 offen lds
    s_add_u32 m0, s36, 66560
    s_add_u32 s40, s35, 99328
    buffer_load_dwordx4 v7, s[20:23], s38 offen lds
    s_add_u32 m0, s36, 82944
    s_nop 0
    buffer_load_dwordx4 v10, s[24:27], s40 offen lds
    s_add_u32 m0, s36, 67584
    s_add_u32 s40, s35, 100352
    buffer_load_dwordx4 v8, s[20:23], s38 offen lds
    s_add_u32 m0, s36, 83968
    s_nop 0
    buffer_load_dwordx4 v10, s[24:27], s40 offen lds
    s_add_u32 m0, s36, 68608
    s_add_u32 s40, s35, 101376
    buffer_load_dwordx4 v9, s[20:23], s38 offen lds
    s_add_u32 m0, s36, 84992
    s_nop 0
    buffer_load_dwordx4 v10, s[24:27], s40 offen lds
    s_waitcnt vmcnt(16)
    s_barrier
    s_add_u32 s38, s34, 1792
    s_add_u32 m0, s36, 98304
    s_add_u32 s40, s35, 114688
    buffer_load_dwordx4 v6, s[20:23], s38 offen lds
    s_add_u32 m0, s36, 114688
    s_nop 0
    buffer_load_dwordx4 v10, s[24:27], s40 offen lds
    s_add_u32 m0, s36, 99328
    s_add_u32 s40, s35, 115712
    buffer_load_dwordx4 v7, s[20:23], s38 offen lds
    s_add_u32 m0, s36, 115712
    s_nop 0
    buffer_load_dwordx4 v10, s[24:27], s40 offen lds
    s_add_u32 m0, s36, 100352
    s_add_u32 s40, s35, 116736
    buffer_load_dwordx4 v8, s[20:23], s38 offen lds
    s_add_u32 m0, s36, 116736
    s_nop 0
    buffer_load_dwordx4 v10, s[24:27], s40 offen lds
    s_add_u32 m0, s36, 101376
    s_add_u32 s40, s35, 117760
    buffer_load_dwordx4 v9, s[20:23], s38 offen lds
    s_add_u32 m0, s36, 117760
    s_nop 0
    buffer_load_dwordx4 v10, s[24:27], s40 offen lds
    s_waitcnt vmcnt(16)
    s_barrier
    s_add_u32 s38, s34, 2048
    s_add_u32 m0, s36, 0
    s_add_u32 s40, s35, 131072
    buffer_load_dwordx4 v6, s[20:23], s38 offen lds
    s_add_u32 m0, s36, 16384
    s_nop 0
    buffer_load_dwordx4 v10, s[24:27], s40 offen lds
    s_add_u32 m0, s36, 1024
    s_add_u32 s40, s35, 132096
    buffer_load_dwordx4 v7, s[20:23], s38 offen lds
    s_add_u32 m0, s36, 17408
    s_nop 0
    buffer_load_dwordx4 v10, s[24:27], s40 offen lds
    s_add_u32 m0, s36, 2048
    s_add_u32 s40, s35, 133120
    buffer_load_dwordx4 v8, s[20:23], s38 offen lds
    s_add_u32 m0, s36, 18432
    s_nop 0
    buffer_load_dwordx4 v10, s[24:27], s40 offen lds
    s_add_u32 m0, s36, 3072
    s_add_u32 s40, s35, 134144
    buffer_load_dwordx4 v9, s[20:23], s38 offen lds
    s_add_u32 m0, s36, 19456
    s_nop 0
    buffer_load_dwordx4 v10, s[24:27], s40 offen lds
    s_waitcnt vmcnt(16)
    s_barrier
    s_add_u32 s38, s34, 2304
    s_add_u32 m0, s36, 32768
    s_add_u32 s40, s35, 147456
    buffer_load_dwordx4 v6, s[20:23], s38 offen lds
    s_add_u32 m0, s36, 49152
    s_nop 0
    buffer_load_dwordx4 v10, s[24:27], s40 offen lds
    s_add_u32 m0, s36, 33792
    s_add_u32 s40, s35, 148480
    buffer_load_dwordx4 v7, s[20:23], s38 offen lds
    s_add_u32 m0, s36, 50176
    s_nop 0
    buffer_load_dwordx4 v10, s[24:27], s40 offen lds
    s_add_u32 m0, s36, 34816
    s_add_u32 s40, s35, 149504
    buffer_load_dwordx4 v8, s[20:23], s38 offen lds
    s_add_u32 m0, s36, 51200
    s_nop 0
    buffer_load_dwordx4 v10, s[24:27], s40 offen lds
    s_add_u32 m0, s36, 35840
    s_add_u32 s40, s35, 150528
    buffer_load_dwordx4 v9, s[20:23], s38 offen lds
    s_add_u32 m0, s36, 52224
    s_nop 0
    buffer_load_dwordx4 v10, s[24:27], s40 offen lds
    s_waitcnt vmcnt(16)
    s_barrier
    s_add_u32 s38, s34, 2560
    s_add_u32 m0, s36, 65536
    s_add_u32 s40, s35, 163840
    buffer_load_dwordx4 v6, s[20:23], s38 offen lds
    s_add_u32 m0, s36, 81920
    s_nop 0
    buffer_load_dwordx4 v10, s[24:27], s40 offen lds
    s_add_u32 m0, s36, 66560
    s_add_u32 s40, s35, 164864
    buffer_load_dwordx4 v7, s[20:23], s38 offen lds
    s_add_u32 m0, s36, 82944
    s_nop 0
    buffer_load_dwordx4 v10, s[24:27], s40 offen lds
    s_add_u32 m0, s36, 67584
    s_add_u32 s40, s35, 165888
    buffer_load_dwordx4 v8, s[20:23], s38 offen lds
    s_add_u32 m0, s36, 83968
    s_nop 0
    buffer_load_dwordx4 v10, s[24:27], s40 offen lds
    s_add_u32 m0, s36, 68608
    s_add_u32 s40, s35, 166912
    buffer_load_dwordx4 v9, s[20:23], s38 offen lds
    s_add_u32 m0, s36, 84992
    s_nop 0
    buffer_load_dwordx4 v10, s[24:27], s40 offen lds
    s_waitcnt vmcnt(16)
    s_barrier
    s_add_u32 s38, s34, 2816
    s_add_u32 m0, s36, 98304
    s_add_u32 s40, s35, 180224
    buffer_load_dwordx4 v6, s[20:23], s38 offen lds
    s_add_u32 m0, s36, 114688
    s_nop 0
    buffer_load_dwordx4 v10, s[24:27], s40 offen lds
    s_add_u32 m0, s36, 99328
    s_add_u32 s40, s35, 181248
    buffer_load_dwordx4 v7, s[20:23], s38 offen lds
    s_add_u32 m0, s36, 115712
    s_nop 0
    buffer_load_dwordx4 v10, s[24:27], s40 offen lds
    s_add_u32 m0, s36, 100352
    s_add_u32 s40, s35, 182272
    buffer_load_dwordx4 v8, s[20:23], s38 offen lds
    s_add_u32 m0, s36, 116736
    s_nop 0
    buffer_load_dwordx4 v10, s[24:27], s40 offen lds
    s_add_u32 m0, s36, 101376
    s_add_u32 s40, s35, 183296
    buffer_load_dwordx4 v9, s[20:23], s38 offen lds
    s_add_u32 m0, s36, 117760
    s_nop 0
    buffer_load_dwordx4 v10, s[24:27], s40 offen lds
    s_waitcnt vmcnt(16)
    s_barrier
    s_add_u32 s38, s34, 3072
    s_add_u32 m0, s36, 0
    s_add_u32 s40, s35, 196608
    buffer_load_dwordx4 v6, s[20:23], s38 offen lds
    s_add_u32 m0, s36, 16384
    s_nop 0
    buffer_load_dwordx4 v10, s[24:27], s40 offen lds
    s_add_u32 m0, s36, 1024
    s_add_u32 s40, s35, 197632
    buffer_load_dwordx4 v7, s[20:23], s38 offen lds
    s_add_u32 m0, s36, 17408
    s_nop 0
    buffer_load_dwordx4 v10, s[24:27], s40 offen lds
    s_add_u32 m0, s36, 2048
    s_add_u32 s40, s35, 198656
    buffer_load_dwordx4 v8, s[20:23], s38 offen lds
    s_add_u32 m0, s36, 18432
    s_nop 0
    buffer_load_dwordx4 v10, s[24:27], s40 offen lds
    s_add_u32 m0, s36, 3072
    s_add_u32 s40, s35, 199680
    buffer_load_dwordx4 v9, s[20:23], s38 offen lds
    s_add_u32 m0, s36, 19456
    s_nop 0
    buffer_load_dwordx4 v10, s[24:27], s40 offen lds
    s_waitcnt vmcnt(16)
    s_barrier
    s_add_u32 s38, s34, 3328
    s_add_u32 m0, s36, 32768
    s_add_u32 s40, s35, 212992
    buffer_load_dwordx4 v6, s[20:23], s38 offen lds
    s_add_u32 m0, s36, 49152
    s_nop 0
    buffer_load_dwordx4 v10, s[24:27], s40 offen lds
    s_add_u32 m0, s36, 33792
    s_add_u32 s40, s35, 214016
    buffer_load_dwordx4 v7, s[20:23], s38 offen lds
    s_add_u32 m0, s36, 50176
    s_nop 0
    buffer_load_dwordx4 v10, s[24:27], s40 offen lds
    s_add_u32 m0, s36, 34816
    s_add_u32 s40, s35, 215040
    buffer_load_dwordx4 v8, s[20:23], s38 offen lds
    s_add_u32 m0, s36, 51200
    s_nop 0
    buffer_load_dwordx4 v10, s[24:27], s40 offen lds
    s_add_u32 m0, s36, 35840
    s_add_u32 s40, s35, 216064
    buffer_load_dwordx4 v9, s[20:23], s38 offen lds
    s_add_u32 m0, s36, 52224
    s_nop 0
    buffer_load_dwordx4 v10, s[24:27], s40 offen lds
    s_waitcnt vmcnt(16)
    s_barrier
    s_waitcnt vmcnt(8)
    s_barrier
    s_waitcnt vmcnt(0)
    s_barrier
    s_branch K4_FIN
K4_CONS:
    v_and_b32 v11, 31, v0
    v_lshrrev_b32 v12, 5, v0
    s_lshr_b32 s40, s18, 1
    s_lshl_b32 s40, s40, 5
    v_add_u32 v13, s40, v11
    v_and_b32 v14, 15, v13
    v_lshlrev_b32 v13, 8, v13

    v_add_u32 v15, 0, v12
    v_xor_b32 v15, v15, v14
    v_lshl_add_u32 v16, v15, 4, v13
    v_add_u32 v24, 65536, v16
    v_add_u32 v15, 2, v12
    v_xor_b32 v15, v15, v14
    v_lshl_add_u32 v17, v15, 4, v13
    v_add_u32 v25, 65536, v17
    v_add_u32 v15, 4, v12
    v_xor_b32 v15, v15, v14
    v_lshl_add_u32 v18, v15, 4, v13
    v_add_u32 v26, 65536, v18
    v_add_u32 v15, 6, v12
    v_xor_b32 v15, v15, v14
    v_lshl_add_u32 v19, v15, 4, v13
    v_add_u32 v27, 65536, v19
    v_add_u32 v15, 8, v12
    v_xor_b32 v15, v15, v14
    v_lshl_add_u32 v20, v15, 4, v13
    v_add_u32 v28, 65536, v20
    v_add_u32 v15, 10, v12
    v_xor_b32 v15, v15, v14
    v_lshl_add_u32 v21, v15, 4, v13
    v_add_u32 v29, 65536, v21
    v_add_u32 v15, 12, v12
    v_xor_b32 v15, v15, v14
    v_lshl_add_u32 v22, v15, 4, v13
    v_add_u32 v30, 65536, v22
    v_add_u32 v15, 14, v12
    v_xor_b32 v15, v15, v14
    v_lshl_add_u32 v23, v15, 4, v13
    v_add_u32 v31, 65536, v23
    v_lshrrev_b32 v14, 2, v3
    v_lshl_add_u32 v15, v12, 3, v14
    v_and_b32 v13, 1, v2
    v_lshlrev_b32 v13, 5, v13
    v_and_b32 v34, 3, v3
    v_lshl_add_u32 v13, v34, 3, v13
    s_and_b32 s40, s18, 1
    s_lshl_b32 s40, s40, 6
    v_add_u32 v13, s40, v13
    v_lshrrev_b32 v14, 1, v14
    v_lshlrev_b32 v14, 6, v14
    v_xor_b32 v13, v13, v14
    v_lshl_add_u32 v13, v15, 7, v13
    v_add_u32 v32, 16384, v13
    v_add_u32 v33, 81920, v13

    s_lshl_b32 s40, s16, 6
    s_lshr_b32 s41, s18, 1
    s_lshl_b32 s41, s41, 5
    s_add_u32 s40, s40, s41
    v_add_u32 v34, s40, v11
    v_lshlrev_b32 v34, 10, v34
    v_lshl_add_u32 v34, v12, 3, v34
    s_lshl_b32 s40, s17, 7
    s_and_b32 s41, s18, 1
    s_lshl_b32 s41, s41, 6
    s_add_u32 s40, s40, s41
    v_add_u32 v34, s40, v34
    v_add_u32 v35, 3145728, v34

    s_barrier
    ds_read_b64_tr_b16 v[64:65], v32 offset:0
    ds_read_b64_tr_b16 v[66:67], v32 offset:512
    ds_read_b128 v[68:71], v16 offset:0
    ds_read_b64_tr_b16 v[72:73], v32 offset:2048
    ds_read_b64_tr_b16 v[74:75], v32 offset:2560
    ds_read_b128 v[76:79], v17 offset:0
    ds_read_b64_tr_b16 v[80:81], v32 offset:4096
    ds_read_b64_tr_b16 v[82:83], v32 offset:4608
    ds_read_b128 v[84:87], v18 offset:0
    ds_read_b64_tr_b16 v[88:89], v32 offset:6144
    ds_read_b64_tr_b16 v[90:91], v32 offset:6656
    ds_read_b128 v[92:95], v19 offset:0
    ds_read_b64_tr_b16 v[96:97], v32 offset:8192
    ds_read_b64_tr_b16 v[98:99], v32 offset:8704
    ds_read_b128 v[100:103], v20 offset:0
    s_waitcnt lgkmcnt(12)
    v_mfma_f32_32x32x16_bf16 v[48:63], v[64:67], v[68:71], 0
    ds_read_b64_tr_b16 v[104:105], v32 offset:10240
    ds_read_b64_tr_b16 v[106:107], v32 offset:10752
    ds_read_b128 v[108:111], v21 offset:0
    s_waitcnt lgkmcnt(12)
    v_mfma_f32_32x32x16_bf16 v[48:63], v[72:75], v[76:79], v[48:63]
    ds_read_b64_tr_b16 v[112:113], v32 offset:12288
    ds_read_b64_tr_b16 v[114:115], v32 offset:12800
    ds_read_b128 v[116:119], v22 offset:0
    s_waitcnt lgkmcnt(12)
    v_mfma_f32_32x32x16_bf16 v[48:63], v[80:83], v[84:87], v[48:63]
    ds_read_b64_tr_b16 v[120:121], v32 offset:14336
    ds_read_b64_tr_b16 v[122:123], v32 offset:14848
    ds_read_b128 v[124:127], v23 offset:0
    s_waitcnt lgkmcnt(12)
    v_mfma_f32_32x32x16_bf16 v[48:63], v[88:91], v[92:95], v[48:63]
    s_waitcnt lgkmcnt(9)
    v_mfma_f32_32x32x16_bf16 v[48:63], v[96:99], v[100:103], v[48:63]
    s_waitcnt lgkmcnt(6)
    v_mfma_f32_32x32x16_bf16 v[48:63], v[104:107], v[108:111], v[48:63]
    s_waitcnt lgkmcnt(3)
    v_mfma_f32_32x32x16_bf16 v[48:63], v[112:115], v[116:119], v[48:63]
    s_waitcnt lgkmcnt(0)
    v_mfma_f32_32x32x16_bf16 v[48:63], v[120:123], v[124:127], v[48:63]
    s_barrier
    ds_read_b64_tr_b16 v[64:65], v32 offset:32768
    ds_read_b64_tr_b16 v[66:67], v32 offset:33280
    ds_read_b128 v[68:71], v16 offset:32768
    ds_read_b64_tr_b16 v[72:73], v32 offset:34816
    ds_read_b64_tr_b16 v[74:75], v32 offset:35328
    ds_read_b128 v[76:79], v17 offset:32768
    ds_read_b64_tr_b16 v[80:81], v32 offset:36864
    ds_read_b64_tr_b16 v[82:83], v32 offset:37376
    ds_read_b128 v[84:87], v18 offset:32768
    ds_read_b64_tr_b16 v[88:89], v32 offset:38912
    ds_read_b64_tr_b16 v[90:91], v32 offset:39424
    ds_read_b128 v[92:95], v19 offset:32768
    ds_read_b64_tr_b16 v[96:97], v32 offset:40960
    ds_read_b64_tr_b16 v[98:99], v32 offset:41472
    ds_read_b128 v[100:103], v20 offset:32768
    s_waitcnt lgkmcnt(12)
    v_mfma_f32_32x32x16_bf16 v[48:63], v[64:67], v[68:71], v[48:63]
    ds_read_b64_tr_b16 v[104:105], v32 offset:43008
    ds_read_b64_tr_b16 v[106:107], v32 offset:43520
    ds_read_b128 v[108:111], v21 offset:32768
    s_waitcnt lgkmcnt(12)
    v_mfma_f32_32x32x16_bf16 v[48:63], v[72:75], v[76:79], v[48:63]
    ds_read_b64_tr_b16 v[112:113], v32 offset:45056
    ds_read_b64_tr_b16 v[114:115], v32 offset:45568
    ds_read_b128 v[116:119], v22 offset:32768
    s_waitcnt lgkmcnt(12)
    v_mfma_f32_32x32x16_bf16 v[48:63], v[80:83], v[84:87], v[48:63]
    ds_read_b64_tr_b16 v[120:121], v32 offset:47104
    ds_read_b64_tr_b16 v[122:123], v32 offset:47616
    ds_read_b128 v[124:127], v23 offset:32768
    s_waitcnt lgkmcnt(12)
    v_mfma_f32_32x32x16_bf16 v[48:63], v[88:91], v[92:95], v[48:63]
    s_waitcnt lgkmcnt(9)
    v_mfma_f32_32x32x16_bf16 v[48:63], v[96:99], v[100:103], v[48:63]
    s_waitcnt lgkmcnt(6)
    v_mfma_f32_32x32x16_bf16 v[48:63], v[104:107], v[108:111], v[48:63]
    s_waitcnt lgkmcnt(3)
    v_mfma_f32_32x32x16_bf16 v[48:63], v[112:115], v[116:119], v[48:63]
    s_waitcnt lgkmcnt(0)
    v_mfma_f32_32x32x16_bf16 v[48:63], v[120:123], v[124:127], v[48:63]
    s_barrier
    ds_read_b64_tr_b16 v[64:65], v33 offset:0
    ds_read_b64_tr_b16 v[66:67], v33 offset:512
    ds_read_b128 v[68:71], v24 offset:0
    ds_read_b64_tr_b16 v[72:73], v33 offset:2048
    ds_read_b64_tr_b16 v[74:75], v33 offset:2560
    ds_read_b128 v[76:79], v25 offset:0
    ds_read_b64_tr_b16 v[80:81], v33 offset:4096
    ds_read_b64_tr_b16 v[82:83], v33 offset:4608
    ds_read_b128 v[84:87], v26 offset:0
    ds_read_b64_tr_b16 v[88:89], v33 offset:6144
    ds_read_b64_tr_b16 v[90:91], v33 offset:6656
    ds_read_b128 v[92:95], v27 offset:0
    ds_read_b64_tr_b16 v[96:97], v33 offset:8192
    ds_read_b64_tr_b16 v[98:99], v33 offset:8704
    ds_read_b128 v[100:103], v28 offset:0
    s_waitcnt lgkmcnt(12)
    v_mfma_f32_32x32x16_bf16 v[48:63], v[64:67], v[68:71], v[48:63]
    ds_read_b64_tr_b16 v[104:105], v33 offset:10240
    ds_read_b64_tr_b16 v[106:107], v33 offset:10752
    ds_read_b128 v[108:111], v29 offset:0
    s_waitcnt lgkmcnt(12)
    v_mfma_f32_32x32x16_bf16 v[48:63], v[72:75], v[76:79], v[48:63]
    ds_read_b64_tr_b16 v[112:113], v33 offset:12288
    ds_read_b64_tr_b16 v[114:115], v33 offset:12800
    ds_read_b128 v[116:119], v30 offset:0
    s_waitcnt lgkmcnt(12)
    v_mfma_f32_32x32x16_bf16 v[48:63], v[80:83], v[84:87], v[48:63]
    ds_read_b64_tr_b16 v[120:121], v33 offset:14336
    ds_read_b64_tr_b16 v[122:123], v33 offset:14848
    ds_read_b128 v[124:127], v31 offset:0
    s_waitcnt lgkmcnt(12)
    v_mfma_f32_32x32x16_bf16 v[48:63], v[88:91], v[92:95], v[48:63]
    s_waitcnt lgkmcnt(9)
    v_mfma_f32_32x32x16_bf16 v[48:63], v[96:99], v[100:103], v[48:63]
    s_waitcnt lgkmcnt(6)
    v_mfma_f32_32x32x16_bf16 v[48:63], v[104:107], v[108:111], v[48:63]
    s_waitcnt lgkmcnt(3)
    v_mfma_f32_32x32x16_bf16 v[48:63], v[112:115], v[116:119], v[48:63]
    s_waitcnt lgkmcnt(0)
    v_mfma_f32_32x32x16_bf16 v[48:63], v[120:123], v[124:127], v[48:63]
    s_barrier
    ds_read_b64_tr_b16 v[64:65], v33 offset:32768
    ds_read_b64_tr_b16 v[66:67], v33 offset:33280
    ds_read_b128 v[68:71], v24 offset:32768
    ds_read_b64_tr_b16 v[72:73], v33 offset:34816
    ds_read_b64_tr_b16 v[74:75], v33 offset:35328
    ds_read_b128 v[76:79], v25 offset:32768
    ds_read_b64_tr_b16 v[80:81], v33 offset:36864
    ds_read_b64_tr_b16 v[82:83], v33 offset:37376
    ds_read_b128 v[84:87], v26 offset:32768
    ds_read_b64_tr_b16 v[88:89], v33 offset:38912
    ds_read_b64_tr_b16 v[90:91], v33 offset:39424
    ds_read_b128 v[92:95], v27 offset:32768
    ds_read_b64_tr_b16 v[96:97], v33 offset:40960
    ds_read_b64_tr_b16 v[98:99], v33 offset:41472
    ds_read_b128 v[100:103], v28 offset:32768
    s_waitcnt lgkmcnt(12)
    v_mfma_f32_32x32x16_bf16 v[48:63], v[64:67], v[68:71], v[48:63]
    ds_read_b64_tr_b16 v[104:105], v33 offset:43008
    ds_read_b64_tr_b16 v[106:107], v33 offset:43520
    ds_read_b128 v[108:111], v29 offset:32768
    s_waitcnt lgkmcnt(12)
    v_mfma_f32_32x32x16_bf16 v[48:63], v[72:75], v[76:79], v[48:63]
    ds_read_b64_tr_b16 v[112:113], v33 offset:45056
    ds_read_b64_tr_b16 v[114:115], v33 offset:45568
    ds_read_b128 v[116:119], v30 offset:32768
    s_waitcnt lgkmcnt(12)
    v_mfma_f32_32x32x16_bf16 v[48:63], v[80:83], v[84:87], v[48:63]
    ds_read_b64_tr_b16 v[120:121], v33 offset:47104
    ds_read_b64_tr_b16 v[122:123], v33 offset:47616
    ds_read_b128 v[124:127], v31 offset:32768
    s_waitcnt lgkmcnt(12)
    v_mfma_f32_32x32x16_bf16 v[48:63], v[88:91], v[92:95], v[48:63]
    s_waitcnt lgkmcnt(9)
    v_mfma_f32_32x32x16_bf16 v[48:63], v[96:99], v[100:103], v[48:63]
    s_waitcnt lgkmcnt(6)
    v_mfma_f32_32x32x16_bf16 v[48:63], v[104:107], v[108:111], v[48:63]
    s_waitcnt lgkmcnt(3)
    v_mfma_f32_32x32x16_bf16 v[48:63], v[112:115], v[116:119], v[48:63]
    s_waitcnt lgkmcnt(0)
    v_mfma_f32_32x32x16_bf16 v[48:63], v[120:123], v[124:127], v[48:63]
    s_barrier
    ds_read_b64_tr_b16 v[64:65], v32 offset:0
    ds_read_b64_tr_b16 v[66:67], v32 offset:512
    ds_read_b128 v[68:71], v16 offset:0
    ds_read_b64_tr_b16 v[72:73], v32 offset:2048
    ds_read_b64_tr_b16 v[74:75], v32 offset:2560
    ds_read_b128 v[76:79], v17 offset:0
    ds_read_b64_tr_b16 v[80:81], v32 offset:4096
    ds_read_b64_tr_b16 v[82:83], v32 offset:4608
    ds_read_b128 v[84:87], v18 offset:0
    ds_read_b64_tr_b16 v[88:89], v32 offset:6144
    ds_read_b64_tr_b16 v[90:91], v32 offset:6656
    ds_read_b128 v[92:95], v19 offset:0
    ds_read_b64_tr_b16 v[96:97], v32 offset:8192
    ds_read_b64_tr_b16 v[98:99], v32 offset:8704
    ds_read_b128 v[100:103], v20 offset:0
    s_waitcnt lgkmcnt(12)
    v_mfma_f32_32x32x16_bf16 v[48:63], v[64:67], v[68:71], v[48:63]
    ds_read_b64_tr_b16 v[104:105], v32 offset:10240
    ds_read_b64_tr_b16 v[106:107], v32 offset:10752
    ds_read_b128 v[108:111], v21 offset:0
    s_waitcnt lgkmcnt(12)
    v_mfma_f32_32x32x16_bf16 v[48:63], v[72:75], v[76:79], v[48:63]
    ds_read_b64_tr_b16 v[112:113], v32 offset:12288
    ds_read_b64_tr_b16 v[114:115], v32 offset:12800
    ds_read_b128 v[116:119], v22 offset:0
    s_waitcnt lgkmcnt(12)
    v_mfma_f32_32x32x16_bf16 v[48:63], v[80:83], v[84:87], v[48:63]
    ds_read_b64_tr_b16 v[120:121], v32 offset:14336
    ds_read_b64_tr_b16 v[122:123], v32 offset:14848
    ds_read_b128 v[124:127], v23 offset:0
    s_waitcnt lgkmcnt(12)
    v_mfma_f32_32x32x16_bf16 v[48:63], v[88:91], v[92:95], v[48:63]
    s_waitcnt lgkmcnt(9)
    v_mfma_f32_32x32x16_bf16 v[48:63], v[96:99], v[100:103], v[48:63]
    s_waitcnt lgkmcnt(6)
    v_mfma_f32_32x32x16_bf16 v[48:63], v[104:107], v[108:111], v[48:63]
    s_waitcnt lgkmcnt(3)
    v_mfma_f32_32x32x16_bf16 v[48:63], v[112:115], v[116:119], v[48:63]
    s_waitcnt lgkmcnt(0)
    v_mfma_f32_32x32x16_bf16 v[48:63], v[120:123], v[124:127], v[48:63]
    s_barrier
    ds_read_b64_tr_b16 v[64:65], v32 offset:32768
    ds_read_b64_tr_b16 v[66:67], v32 offset:33280
    ds_read_b128 v[68:71], v16 offset:32768
    ds_read_b64_tr_b16 v[72:73], v32 offset:34816
    ds_read_b64_tr_b16 v[74:75], v32 offset:35328
    ds_read_b128 v[76:79], v17 offset:32768
    ds_read_b64_tr_b16 v[80:81], v32 offset:36864
    ds_read_b64_tr_b16 v[82:83], v32 offset:37376
    ds_read_b128 v[84:87], v18 offset:32768
    ds_read_b64_tr_b16 v[88:89], v32 offset:38912
    ds_read_b64_tr_b16 v[90:91], v32 offset:39424
    ds_read_b128 v[92:95], v19 offset:32768
    ds_read_b64_tr_b16 v[96:97], v32 offset:40960
    ds_read_b64_tr_b16 v[98:99], v32 offset:41472
    ds_read_b128 v[100:103], v20 offset:32768
    s_waitcnt lgkmcnt(12)
    v_mfma_f32_32x32x16_bf16 v[48:63], v[64:67], v[68:71], v[48:63]
    ds_read_b64_tr_b16 v[104:105], v32 offset:43008
    ds_read_b64_tr_b16 v[106:107], v32 offset:43520
    ds_read_b128 v[108:111], v21 offset:32768
    s_waitcnt lgkmcnt(12)
    v_mfma_f32_32x32x16_bf16 v[48:63], v[72:75], v[76:79], v[48:63]
    ds_read_b64_tr_b16 v[112:113], v32 offset:45056
    ds_read_b64_tr_b16 v[114:115], v32 offset:45568
    ds_read_b128 v[116:119], v22 offset:32768
    s_waitcnt lgkmcnt(12)
    v_mfma_f32_32x32x16_bf16 v[48:63], v[80:83], v[84:87], v[48:63]
    ds_read_b64_tr_b16 v[120:121], v32 offset:47104
    ds_read_b64_tr_b16 v[122:123], v32 offset:47616
    ds_read_b128 v[124:127], v23 offset:32768
    s_waitcnt lgkmcnt(12)
    v_mfma_f32_32x32x16_bf16 v[48:63], v[88:91], v[92:95], v[48:63]
    s_waitcnt lgkmcnt(9)
    v_mfma_f32_32x32x16_bf16 v[48:63], v[96:99], v[100:103], v[48:63]
    s_waitcnt lgkmcnt(6)
    v_mfma_f32_32x32x16_bf16 v[48:63], v[104:107], v[108:111], v[48:63]
    s_waitcnt lgkmcnt(3)
    v_mfma_f32_32x32x16_bf16 v[48:63], v[112:115], v[116:119], v[48:63]
    s_waitcnt lgkmcnt(0)
    v_mfma_f32_32x32x16_bf16 v[48:63], v[120:123], v[124:127], v[48:63]
    s_barrier
    ds_read_b64_tr_b16 v[64:65], v33 offset:0
    ds_read_b64_tr_b16 v[66:67], v33 offset:512
    ds_read_b128 v[68:71], v24 offset:0
    ds_read_b64_tr_b16 v[72:73], v33 offset:2048
    ds_read_b64_tr_b16 v[74:75], v33 offset:2560
    ds_read_b128 v[76:79], v25 offset:0
    ds_read_b64_tr_b16 v[80:81], v33 offset:4096
    ds_read_b64_tr_b16 v[82:83], v33 offset:4608
    ds_read_b128 v[84:87], v26 offset:0
    ds_read_b64_tr_b16 v[88:89], v33 offset:6144
    ds_read_b64_tr_b16 v[90:91], v33 offset:6656
    ds_read_b128 v[92:95], v27 offset:0
    ds_read_b64_tr_b16 v[96:97], v33 offset:8192
    ds_read_b64_tr_b16 v[98:99], v33 offset:8704
    ds_read_b128 v[100:103], v28 offset:0
    s_waitcnt lgkmcnt(12)
    v_mfma_f32_32x32x16_bf16 v[48:63], v[64:67], v[68:71], v[48:63]
    ds_read_b64_tr_b16 v[104:105], v33 offset:10240
    ds_read_b64_tr_b16 v[106:107], v33 offset:10752
    ds_read_b128 v[108:111], v29 offset:0
    s_waitcnt lgkmcnt(12)
    v_mfma_f32_32x32x16_bf16 v[48:63], v[72:75], v[76:79], v[48:63]
    ds_read_b64_tr_b16 v[112:113], v33 offset:12288
    ds_read_b64_tr_b16 v[114:115], v33 offset:12800
    ds_read_b128 v[116:119], v30 offset:0
    s_waitcnt lgkmcnt(12)
    v_mfma_f32_32x32x16_bf16 v[48:63], v[80:83], v[84:87], v[48:63]
    ds_read_b64_tr_b16 v[120:121], v33 offset:14336
    ds_read_b64_tr_b16 v[122:123], v33 offset:14848
    ds_read_b128 v[124:127], v31 offset:0
    s_waitcnt lgkmcnt(12)
    v_mfma_f32_32x32x16_bf16 v[48:63], v[88:91], v[92:95], v[48:63]
    s_waitcnt lgkmcnt(9)
    v_mfma_f32_32x32x16_bf16 v[48:63], v[96:99], v[100:103], v[48:63]
    s_waitcnt lgkmcnt(6)
    v_mfma_f32_32x32x16_bf16 v[48:63], v[104:107], v[108:111], v[48:63]
    s_waitcnt lgkmcnt(3)
    v_mfma_f32_32x32x16_bf16 v[48:63], v[112:115], v[116:119], v[48:63]
    s_waitcnt lgkmcnt(0)
    v_mfma_f32_32x32x16_bf16 v[48:63], v[120:123], v[124:127], v[48:63]
    s_barrier
    ds_read_b64_tr_b16 v[64:65], v33 offset:32768
    ds_read_b64_tr_b16 v[66:67], v33 offset:33280
    ds_read_b128 v[68:71], v24 offset:32768
    ds_read_b64_tr_b16 v[72:73], v33 offset:34816
    ds_read_b64_tr_b16 v[74:75], v33 offset:35328
    ds_read_b128 v[76:79], v25 offset:32768
    ds_read_b64_tr_b16 v[80:81], v33 offset:36864
    ds_read_b64_tr_b16 v[82:83], v33 offset:37376
    ds_read_b128 v[84:87], v26 offset:32768
    ds_read_b64_tr_b16 v[88:89], v33 offset:38912
    ds_read_b64_tr_b16 v[90:91], v33 offset:39424
    ds_read_b128 v[92:95], v27 offset:32768
    ds_read_b64_tr_b16 v[96:97], v33 offset:40960
    ds_read_b64_tr_b16 v[98:99], v33 offset:41472
    ds_read_b128 v[100:103], v28 offset:32768
    s_waitcnt lgkmcnt(12)
    v_mfma_f32_32x32x16_bf16 v[48:63], v[64:67], v[68:71], v[48:63]
    ds_read_b64_tr_b16 v[104:105], v33 offset:43008
    ds_read_b64_tr_b16 v[106:107], v33 offset:43520
    ds_read_b128 v[108:111], v29 offset:32768
    s_waitcnt lgkmcnt(12)
    v_mfma_f32_32x32x16_bf16 v[48:63], v[72:75], v[76:79], v[48:63]
    ds_read_b64_tr_b16 v[112:113], v33 offset:45056
    ds_read_b64_tr_b16 v[114:115], v33 offset:45568
    ds_read_b128 v[116:119], v30 offset:32768
    s_waitcnt lgkmcnt(12)
    v_mfma_f32_32x32x16_bf16 v[48:63], v[80:83], v[84:87], v[48:63]
    ds_read_b64_tr_b16 v[120:121], v33 offset:47104
    ds_read_b64_tr_b16 v[122:123], v33 offset:47616
    ds_read_b128 v[124:127], v31 offset:32768
    s_waitcnt lgkmcnt(12)
    v_mfma_f32_32x32x16_bf16 v[48:63], v[88:91], v[92:95], v[48:63]
    s_waitcnt lgkmcnt(9)
    v_mfma_f32_32x32x16_bf16 v[48:63], v[96:99], v[100:103], v[48:63]
    s_waitcnt lgkmcnt(6)
    v_mfma_f32_32x32x16_bf16 v[48:63], v[104:107], v[108:111], v[48:63]
    s_waitcnt lgkmcnt(3)
    v_mfma_f32_32x32x16_bf16 v[48:63], v[112:115], v[116:119], v[48:63]
    s_waitcnt lgkmcnt(0)
    v_mfma_f32_32x32x16_bf16 v[48:63], v[120:123], v[124:127], v[48:63]
    s_barrier
    ds_read_b64_tr_b16 v[64:65], v32 offset:0
    ds_read_b64_tr_b16 v[66:67], v32 offset:512
    ds_read_b128 v[68:71], v16 offset:0
    ds_read_b64_tr_b16 v[72:73], v32 offset:2048
    ds_read_b64_tr_b16 v[74:75], v32 offset:2560
    ds_read_b128 v[76:79], v17 offset:0
    ds_read_b64_tr_b16 v[80:81], v32 offset:4096
    ds_read_b64_tr_b16 v[82:83], v32 offset:4608
    ds_read_b128 v[84:87], v18 offset:0
    ds_read_b64_tr_b16 v[88:89], v32 offset:6144
    ds_read_b64_tr_b16 v[90:91], v32 offset:6656
    ds_read_b128 v[92:95], v19 offset:0
    ds_read_b64_tr_b16 v[96:97], v32 offset:8192
    ds_read_b64_tr_b16 v[98:99], v32 offset:8704
    ds_read_b128 v[100:103], v20 offset:0
    s_waitcnt lgkmcnt(12)
    v_mfma_f32_32x32x16_bf16 v[48:63], v[64:67], v[68:71], v[48:63]
    ds_read_b64_tr_b16 v[104:105], v32 offset:10240
    ds_read_b64_tr_b16 v[106:107], v32 offset:10752
    ds_read_b128 v[108:111], v21 offset:0
    s_waitcnt lgkmcnt(12)
    v_mfma_f32_32x32x16_bf16 v[48:63], v[72:75], v[76:79], v[48:63]
    ds_read_b64_tr_b16 v[112:113], v32 offset:12288
    ds_read_b64_tr_b16 v[114:115], v32 offset:12800
    ds_read_b128 v[116:119], v22 offset:0
    s_waitcnt lgkmcnt(12)
    v_mfma_f32_32x32x16_bf16 v[48:63], v[80:83], v[84:87], v[48:63]
    ds_read_b64_tr_b16 v[120:121], v32 offset:14336
    ds_read_b64_tr_b16 v[122:123], v32 offset:14848
    ds_read_b128 v[124:127], v23 offset:0
    s_waitcnt lgkmcnt(12)
    v_mfma_f32_32x32x16_bf16 v[48:63], v[88:91], v[92:95], v[48:63]
    s_waitcnt lgkmcnt(9)
    v_mfma_f32_32x32x16_bf16 v[48:63], v[96:99], v[100:103], v[48:63]
    s_waitcnt lgkmcnt(6)
    v_mfma_f32_32x32x16_bf16 v[48:63], v[104:107], v[108:111], v[48:63]
    s_waitcnt lgkmcnt(3)
    v_mfma_f32_32x32x16_bf16 v[48:63], v[112:115], v[116:119], v[48:63]
    s_waitcnt lgkmcnt(0)
    v_mfma_f32_32x32x16_bf16 v[48:63], v[120:123], v[124:127], v[48:63]
    s_barrier
    ds_read_b64_tr_b16 v[64:65], v32 offset:32768
    ds_read_b64_tr_b16 v[66:67], v32 offset:33280
    ds_read_b128 v[68:71], v16 offset:32768
    ds_read_b64_tr_b16 v[72:73], v32 offset:34816
    ds_read_b64_tr_b16 v[74:75], v32 offset:35328
    ds_read_b128 v[76:79], v17 offset:32768
    ds_read_b64_tr_b16 v[80:81], v32 offset:36864
    ds_read_b64_tr_b16 v[82:83], v32 offset:37376
    ds_read_b128 v[84:87], v18 offset:32768
    ds_read_b64_tr_b16 v[88:89], v32 offset:38912
    ds_read_b64_tr_b16 v[90:91], v32 offset:39424
    ds_read_b128 v[92:95], v19 offset:32768
    ds_read_b64_tr_b16 v[96:97], v32 offset:40960
    ds_read_b64_tr_b16 v[98:99], v32 offset:41472
    ds_read_b128 v[100:103], v20 offset:32768
    s_waitcnt lgkmcnt(12)
    v_mfma_f32_32x32x16_bf16 v[48:63], v[64:67], v[68:71], v[48:63]
    ds_read_b64_tr_b16 v[104:105], v32 offset:43008
    ds_read_b64_tr_b16 v[106:107], v32 offset:43520
    ds_read_b128 v[108:111], v21 offset:32768
    s_waitcnt lgkmcnt(12)
    v_mfma_f32_32x32x16_bf16 v[48:63], v[72:75], v[76:79], v[48:63]
    ds_read_b64_tr_b16 v[112:113], v32 offset:45056
    ds_read_b64_tr_b16 v[114:115], v32 offset:45568
    ds_read_b128 v[116:119], v22 offset:32768
    s_waitcnt lgkmcnt(12)
    v_mfma_f32_32x32x16_bf16 v[48:63], v[80:83], v[84:87], v[48:63]
    ds_read_b64_tr_b16 v[120:121], v32 offset:47104
    ds_read_b64_tr_b16 v[122:123], v32 offset:47616
    ds_read_b128 v[124:127], v23 offset:32768
    s_waitcnt lgkmcnt(12)
    v_mfma_f32_32x32x16_bf16 v[48:63], v[88:91], v[92:95], v[48:63]
    s_waitcnt lgkmcnt(9)
    v_mfma_f32_32x32x16_bf16 v[48:63], v[96:99], v[100:103], v[48:63]
    s_waitcnt lgkmcnt(6)
    v_mfma_f32_32x32x16_bf16 v[48:63], v[104:107], v[108:111], v[48:63]
    s_waitcnt lgkmcnt(3)
    v_mfma_f32_32x32x16_bf16 v[48:63], v[112:115], v[116:119], v[48:63]
    s_waitcnt lgkmcnt(0)
    v_mfma_f32_32x32x16_bf16 v[48:63], v[120:123], v[124:127], v[48:63]
    s_barrier
    ds_read_b64_tr_b16 v[64:65], v33 offset:0
    ds_read_b64_tr_b16 v[66:67], v33 offset:512
    ds_read_b128 v[68:71], v24 offset:0
    ds_read_b64_tr_b16 v[72:73], v33 offset:2048
    ds_read_b64_tr_b16 v[74:75], v33 offset:2560
    ds_read_b128 v[76:79], v25 offset:0
    ds_read_b64_tr_b16 v[80:81], v33 offset:4096
    ds_read_b64_tr_b16 v[82:83], v33 offset:4608
    ds_read_b128 v[84:87], v26 offset:0
    ds_read_b64_tr_b16 v[88:89], v33 offset:6144
    ds_read_b64_tr_b16 v[90:91], v33 offset:6656
    ds_read_b128 v[92:95], v27 offset:0
    ds_read_b64_tr_b16 v[96:97], v33 offset:8192
    ds_read_b64_tr_b16 v[98:99], v33 offset:8704
    ds_read_b128 v[100:103], v28 offset:0
    s_waitcnt lgkmcnt(12)
    v_mfma_f32_32x32x16_bf16 v[48:63], v[64:67], v[68:71], v[48:63]
    ds_read_b64_tr_b16 v[104:105], v33 offset:10240
    ds_read_b64_tr_b16 v[106:107], v33 offset:10752
    ds_read_b128 v[108:111], v29 offset:0
    s_waitcnt lgkmcnt(12)
    v_mfma_f32_32x32x16_bf16 v[48:63], v[72:75], v[76:79], v[48:63]
    ds_read_b64_tr_b16 v[112:113], v33 offset:12288
    ds_read_b64_tr_b16 v[114:115], v33 offset:12800
    ds_read_b128 v[116:119], v30 offset:0
    s_waitcnt lgkmcnt(12)
    v_mfma_f32_32x32x16_bf16 v[48:63], v[80:83], v[84:87], v[48:63]
    ds_read_b64_tr_b16 v[120:121], v33 offset:14336
    ds_read_b64_tr_b16 v[122:123], v33 offset:14848
    ds_read_b128 v[124:127], v31 offset:0
    s_waitcnt lgkmcnt(12)
    v_mfma_f32_32x32x16_bf16 v[48:63], v[88:91], v[92:95], v[48:63]
    s_waitcnt lgkmcnt(9)
    v_mfma_f32_32x32x16_bf16 v[48:63], v[96:99], v[100:103], v[48:63]
    s_waitcnt lgkmcnt(6)
    v_mfma_f32_32x32x16_bf16 v[48:63], v[104:107], v[108:111], v[48:63]
    s_waitcnt lgkmcnt(3)
    v_mfma_f32_32x32x16_bf16 v[48:63], v[112:115], v[116:119], v[48:63]
    s_waitcnt lgkmcnt(0)
    v_mfma_f32_32x32x16_bf16 v[48:63], v[120:123], v[124:127], v[48:63]
    s_barrier
    global_load_dwordx2 v[36:37], v35, s[14:15] offset:0
    global_load_dwordx2 v[38:39], v35, s[14:15] offset:16
    global_load_dwordx2 v[40:41], v35, s[14:15] offset:32
    global_load_dwordx2 v[42:43], v35, s[14:15] offset:48
    ds_read_b64_tr_b16 v[64:65], v33 offset:32768
    ds_read_b64_tr_b16 v[66:67], v33 offset:33280
    ds_read_b128 v[68:71], v24 offset:32768
    ds_read_b64_tr_b16 v[72:73], v33 offset:34816
    ds_read_b64_tr_b16 v[74:75], v33 offset:35328
    ds_read_b128 v[76:79], v25 offset:32768
    ds_read_b64_tr_b16 v[80:81], v33 offset:36864
    ds_read_b64_tr_b16 v[82:83], v33 offset:37376
    ds_read_b128 v[84:87], v26 offset:32768
    ds_read_b64_tr_b16 v[88:89], v33 offset:38912
    ds_read_b64_tr_b16 v[90:91], v33 offset:39424
    ds_read_b128 v[92:95], v27 offset:32768
    ds_read_b64_tr_b16 v[96:97], v33 offset:40960
    ds_read_b64_tr_b16 v[98:99], v33 offset:41472
    ds_read_b128 v[100:103], v28 offset:32768
    s_waitcnt lgkmcnt(12)
    v_mfma_f32_32x32x16_bf16 v[48:63], v[64:67], v[68:71], v[48:63]
    ds_read_b64_tr_b16 v[104:105], v33 offset:43008
    ds_read_b64_tr_b16 v[106:107], v33 offset:43520
    ds_read_b128 v[108:111], v29 offset:32768
    s_waitcnt lgkmcnt(12)
    v_mfma_f32_32x32x16_bf16 v[48:63], v[72:75], v[76:79], v[48:63]
    ds_read_b64_tr_b16 v[112:113], v33 offset:45056
    ds_read_b64_tr_b16 v[114:115], v33 offset:45568
    ds_read_b128 v[116:119], v30 offset:32768
    s_waitcnt lgkmcnt(12)
    v_mfma_f32_32x32x16_bf16 v[48:63], v[80:83], v[84:87], v[48:63]
    ds_read_b64_tr_b16 v[120:121], v33 offset:47104
    ds_read_b64_tr_b16 v[122:123], v33 offset:47616
    ds_read_b128 v[124:127], v31 offset:32768
    s_waitcnt lgkmcnt(12)
    v_mfma_f32_32x32x16_bf16 v[48:63], v[88:91], v[92:95], v[48:63]
    s_waitcnt lgkmcnt(9)
    v_mfma_f32_32x32x16_bf16 v[48:63], v[96:99], v[100:103], v[48:63]
    s_waitcnt lgkmcnt(6)
    v_mfma_f32_32x32x16_bf16 v[48:63], v[104:107], v[108:111], v[48:63]
    s_waitcnt lgkmcnt(3)
    v_mfma_f32_32x32x16_bf16 v[48:63], v[112:115], v[116:119], v[48:63]
    s_waitcnt lgkmcnt(0)
    v_mfma_f32_32x32x16_bf16 v[48:63], v[120:123], v[124:127], v[48:63]
    s_barrier
    ds_read_b64_tr_b16 v[64:65], v32 offset:0
    ds_read_b64_tr_b16 v[66:67], v32 offset:512
    ds_read_b128 v[68:71], v16 offset:0
    ds_read_b64_tr_b16 v[72:73], v32 offset:2048
    ds_read_b64_tr_b16 v[74:75], v32 offset:2560
    ds_read_b128 v[76:79], v17 offset:0
    ds_read_b64_tr_b16 v[80:81], v32 offset:4096
    ds_read_b64_tr_b16 v[82:83], v32 offset:4608
    ds_read_b128 v[84:87], v18 offset:0
    ds_read_b64_tr_b16 v[88:89], v32 offset:6144
    ds_read_b64_tr_b16 v[90:91], v32 offset:6656
    ds_read_b128 v[92:95], v19 offset:0
    ds_read_b64_tr_b16 v[96:97], v32 offset:8192
    ds_read_b64_tr_b16 v[98:99], v32 offset:8704
    ds_read_b128 v[100:103], v20 offset:0
    s_waitcnt lgkmcnt(12)
    v_mfma_f32_32x32x16_bf16 v[48:63], v[64:67], v[68:71], v[48:63]
    ds_read_b64_tr_b16 v[104:105], v32 offset:10240
    ds_read_b64_tr_b16 v[106:107], v32 offset:10752
    ds_read_b128 v[108:111], v21 offset:0
    s_waitcnt lgkmcnt(12)
    v_mfma_f32_32x32x16_bf16 v[48:63], v[72:75], v[76:79], v[48:63]
    ds_read_b64_tr_b16 v[112:113], v32 offset:12288
    ds_read_b64_tr_b16 v[114:115], v32 offset:12800
    ds_read_b128 v[116:119], v22 offset:0
    s_waitcnt lgkmcnt(12)
    v_mfma_f32_32x32x16_bf16 v[48:63], v[80:83], v[84:87], v[48:63]
    ds_read_b64_tr_b16 v[120:121], v32 offset:14336
    ds_read_b64_tr_b16 v[122:123], v32 offset:14848
    ds_read_b128 v[124:127], v23 offset:0
    s_waitcnt lgkmcnt(12)
    v_mfma_f32_32x32x16_bf16 v[48:63], v[88:91], v[92:95], v[48:63]
    s_waitcnt lgkmcnt(9)
    v_mfma_f32_32x32x16_bf16 v[48:63], v[96:99], v[100:103], v[48:63]
    s_waitcnt lgkmcnt(6)
    v_mfma_f32_32x32x16_bf16 v[48:63], v[104:107], v[108:111], v[48:63]
    s_waitcnt lgkmcnt(3)
    v_mfma_f32_32x32x16_bf16 v[48:63], v[112:115], v[116:119], v[48:63]
    s_waitcnt lgkmcnt(0)
    v_mfma_f32_32x32x16_bf16 v[48:63], v[120:123], v[124:127], v[48:63]
    s_barrier
    ds_read_b64_tr_b16 v[64:65], v32 offset:32768
    ds_read_b64_tr_b16 v[66:67], v32 offset:33280
    ds_read_b128 v[68:71], v16 offset:32768
    ds_read_b64_tr_b16 v[72:73], v32 offset:34816
    ds_read_b64_tr_b16 v[74:75], v32 offset:35328
    ds_read_b128 v[76:79], v17 offset:32768
    ds_read_b64_tr_b16 v[80:81], v32 offset:36864
    ds_read_b64_tr_b16 v[82:83], v32 offset:37376
    ds_read_b128 v[84:87], v18 offset:32768
    ds_read_b64_tr_b16 v[88:89], v32 offset:38912
    ds_read_b64_tr_b16 v[90:91], v32 offset:39424
    ds_read_b128 v[92:95], v19 offset:32768
    ds_read_b64_tr_b16 v[96:97], v32 offset:40960
    ds_read_b64_tr_b16 v[98:99], v32 offset:41472
    ds_read_b128 v[100:103], v20 offset:32768
    s_waitcnt lgkmcnt(12)
    v_mfma_f32_32x32x16_bf16 v[48:63], v[64:67], v[68:71], v[48:63]
    ds_read_b64_tr_b16 v[104:105], v32 offset:43008
    ds_read_b64_tr_b16 v[106:107], v32 offset:43520
    ds_read_b128 v[108:111], v21 offset:32768
    s_waitcnt lgkmcnt(12)
    v_mfma_f32_32x32x16_bf16 v[48:63], v[72:75], v[76:79], v[48:63]
    ds_read_b64_tr_b16 v[112:113], v32 offset:45056
    ds_read_b64_tr_b16 v[114:115], v32 offset:45568
    ds_read_b128 v[116:119], v22 offset:32768
    s_waitcnt lgkmcnt(12)
    v_mfma_f32_32x32x16_bf16 v[48:63], v[80:83], v[84:87], v[48:63]
    ds_read_b64_tr_b16 v[120:121], v32 offset:47104
    ds_read_b64_tr_b16 v[122:123], v32 offset:47616
    ds_read_b128 v[124:127], v23 offset:32768
    s_waitcnt lgkmcnt(12)
    v_mfma_f32_32x32x16_bf16 v[48:63], v[88:91], v[92:95], v[48:63]
    s_waitcnt lgkmcnt(9)
    v_mfma_f32_32x32x16_bf16 v[48:63], v[96:99], v[100:103], v[48:63]
    s_waitcnt lgkmcnt(6)
    v_mfma_f32_32x32x16_bf16 v[48:63], v[104:107], v[108:111], v[48:63]
    s_waitcnt lgkmcnt(3)
    v_mfma_f32_32x32x16_bf16 v[48:63], v[112:115], v[116:119], v[48:63]
    s_waitcnt lgkmcnt(0)
    v_mfma_f32_32x32x16_bf16 v[48:63], v[120:123], v[124:127], v[48:63]
    s_mov_b32 s33, 0xffff0000
    s_waitcnt vmcnt(0)
    s_nop 10
    v_cvt_pk_bf16_f32 v64, v48, v49
    v_lshlrev_b32 v65, 16, v64
    v_and_b32 v66, s33, v64
    v_lshlrev_b32 v67, 16, v36
    v_and_b32 v68, s33, v36
    v_add_f32 v65, v65, v67
    v_add_f32 v66, v66, v68
    v_cvt_pk_bf16_f32 v72, v65, v66
    v_cvt_pk_bf16_f32 v64, v50, v51
    v_lshlrev_b32 v65, 16, v64
    v_and_b32 v66, s33, v64
    v_lshlrev_b32 v67, 16, v37
    v_and_b32 v68, s33, v37
    v_add_f32 v65, v65, v67
    v_add_f32 v66, v66, v68
    v_cvt_pk_bf16_f32 v73, v65, v66
    v_cvt_pk_bf16_f32 v64, v52, v53
    v_lshlrev_b32 v65, 16, v64
    v_and_b32 v66, s33, v64
    v_lshlrev_b32 v67, 16, v38
    v_and_b32 v68, s33, v38
    v_add_f32 v65, v65, v67
    v_add_f32 v66, v66, v68
    v_cvt_pk_bf16_f32 v74, v65, v66
    v_cvt_pk_bf16_f32 v64, v54, v55
    v_lshlrev_b32 v65, 16, v64
    v_and_b32 v66, s33, v64
    v_lshlrev_b32 v67, 16, v39
    v_and_b32 v68, s33, v39
    v_add_f32 v65, v65, v67
    v_add_f32 v66, v66, v68
    v_cvt_pk_bf16_f32 v75, v65, v66
    v_cvt_pk_bf16_f32 v64, v56, v57
    v_lshlrev_b32 v65, 16, v64
    v_and_b32 v66, s33, v64
    v_lshlrev_b32 v67, 16, v40
    v_and_b32 v68, s33, v40
    v_add_f32 v65, v65, v67
    v_add_f32 v66, v66, v68
    v_cvt_pk_bf16_f32 v76, v65, v66
    v_cvt_pk_bf16_f32 v64, v58, v59
    v_lshlrev_b32 v65, 16, v64
    v_and_b32 v66, s33, v64
    v_lshlrev_b32 v67, 16, v41
    v_and_b32 v68, s33, v41
    v_add_f32 v65, v65, v67
    v_add_f32 v66, v66, v68
    v_cvt_pk_bf16_f32 v77, v65, v66
    v_cvt_pk_bf16_f32 v64, v60, v61
    v_lshlrev_b32 v65, 16, v64
    v_and_b32 v66, s33, v64
    v_lshlrev_b32 v67, 16, v42
    v_and_b32 v68, s33, v42
    v_add_f32 v65, v65, v67
    v_add_f32 v66, v66, v68
    v_cvt_pk_bf16_f32 v78, v65, v66
    v_cvt_pk_bf16_f32 v64, v62, v63
    v_lshlrev_b32 v65, 16, v64
    v_and_b32 v66, s33, v64
    v_lshlrev_b32 v67, 16, v43
    v_and_b32 v68, s33, v43
    v_add_f32 v65, v65, v67
    v_add_f32 v66, v66, v68
    v_cvt_pk_bf16_f32 v79, v65, v66
    global_store_dwordx2 v34, v[72:73], s[6:7] offset:0
    global_store_dwordx2 v34, v[74:75], s[6:7] offset:16
    global_store_dwordx2 v34, v[76:77], s[6:7] offset:32
    global_store_dwordx2 v34, v[78:79], s[6:7] offset:48
K4_FIN:
K4_END:
    s_endpgm
.section .rodata,"a"
.p2align 6
.amdhsa_kernel k1_qkv_kernel
  .amdhsa_next_free_vgpr 128
  .amdhsa_next_free_sgpr 102
  .amdhsa_accum_offset 128
  .amdhsa_group_segment_fixed_size 0
  .amdhsa_kernarg_size 96
  .amdhsa_user_sgpr_count 2
  .amdhsa_user_sgpr_kernarg_segment_ptr 1
  .amdhsa_system_sgpr_workgroup_id_x 1
  .amdhsa_float_denorm_mode_32 3
.end_amdhsa_kernel
.p2align 6
.amdhsa_kernel k2_attn_kernel
  .amdhsa_next_free_vgpr 256
  .amdhsa_next_free_sgpr 102
  .amdhsa_accum_offset 256
  .amdhsa_group_segment_fixed_size 0
  .amdhsa_kernarg_size 96
  .amdhsa_user_sgpr_count 2
  .amdhsa_user_sgpr_kernarg_segment_ptr 1
  .amdhsa_system_sgpr_workgroup_id_x 1
  .amdhsa_float_denorm_mode_32 3
.end_amdhsa_kernel
.p2align 6
.amdhsa_kernel k3_ffn_up_kernel
  .amdhsa_next_free_vgpr 128
  .amdhsa_next_free_sgpr 102
  .amdhsa_accum_offset 128
  .amdhsa_group_segment_fixed_size 0
  .amdhsa_kernarg_size 96
  .amdhsa_user_sgpr_count 2
  .amdhsa_user_sgpr_kernarg_segment_ptr 1
  .amdhsa_system_sgpr_workgroup_id_x 1
  .amdhsa_float_denorm_mode_32 3
.end_amdhsa_kernel
.p2align 6
.amdhsa_kernel k4_ffn_down_kernel
  .amdhsa_next_free_vgpr 128
  .amdhsa_next_free_sgpr 102
  .amdhsa_accum_offset 128
  .amdhsa_group_segment_fixed_size 0
  .amdhsa_kernarg_size 96
  .amdhsa_user_sgpr_count 2
  .amdhsa_user_sgpr_kernarg_segment_ptr 1
  .amdhsa_system_sgpr_workgroup_id_x 1
  .amdhsa_float_denorm_mode_32 3
.end_amdhsa_kernel
.p2align 6
```
